```python
import torch

def _softmax(x, axis=-1):
    return torch.softmax(x, dim=axis)
def _gelu(x):
    return torch.nn.functional.gelu(x, approximate="tanh")
def _silu(x):
    return torch.nn.functional.silu(x)
def _sigmoid(x):
    return torch.sigmoid(x)
def _layernorm(x, axis=-1, eps=1e-5):
    m = x.mean(dim=axis, keepdim=True)
    v = x.var(dim=axis, keepdim=True, unbiased=False)
    return (x - m) / torch.sqrt(v + eps)
def _scatter_add(tgt, idx, src, axis=0):
    return tgt.clone().index_add_(axis, idx, src)
def _segment_sum(src, seg, n):
    out = torch.zeros((n,) + src.shape[1:], dtype=src.dtype)
    return out.index_add_(0, seg, src)
def _pad(x, pw):
    flat = tuple(v for pair in reversed(pw) for v in pair)
    return torch.nn.functional.pad(x, flat)

kernel_name = 'gated_mix__compressed_kv_cla__dense_activation_relu__prompt'

def setup_inputs():

    _w = (lambda a: (lambda t: t.to(torch.bfloat16) if t.is_floating_point() else t)(torch.as_tensor(a)))
    def _A_setup():
        B, H, Sq, Sk, D, M = 1, 32, 2048, 2048, 128, 576
        Dc = 4 * D
        return {
            "x": _w((lambda *s: torch.randn(*s, dtype=torch.bfloat16) * 0.05)(B, Sq, M)),
            "c_kv": _w((lambda *s: torch.randn(*s, dtype=torch.bfloat16) * 0.8)(B, Sk, Dc)),
            "w_q": _w((lambda *s: torch.randn(*s, dtype=torch.bfloat16) * 6.4)(M, H, D) * (M ** -0.5)),
            "w_uk": _w((lambda *s: torch.randn(*s, dtype=torch.bfloat16) * 6.4)(Dc, H, D) * (Dc ** -0.5)),
            "w_uv": _w((lambda *s: torch.randn(*s, dtype=torch.bfloat16) * 0.8)(Dc, H, D) * (Dc ** -0.5)),
            "w_o": _w((lambda *s: torch.randn(*s, dtype=torch.bfloat16) * 0.8)(H, D, M) * ((H * D) ** -0.5)),
        }
    _A_in = _A_setup()

    def _B_setup():
        B, S, D, Dff = 1, 2048, 576, 4608
        return {
            "x": _w((lambda *s: torch.randn(*s, dtype=torch.bfloat16) * 0.05)(B, S, D)),
            "w1": _w((lambda *s: torch.randn(*s, dtype=torch.bfloat16) * 0.05)(D, Dff)),
            "w2": _w((lambda *s: torch.randn(*s, dtype=torch.bfloat16) * 0.05)(Dff, D)),
        }
    _B_in = _B_setup()

    return {
        "A_x": _A_in["x"],
        "A_c_kv": _A_in["c_kv"],
        "A_w_q": _A_in["w_q"],
        "A_w_uk": _A_in["w_uk"],
        "A_w_uv": _A_in["w_uv"],
        "A_w_o": _A_in["w_o"],
        "B_x": _B_in["x"],
        "B_w1": _B_in["w1"],
        "B_w2": _B_in["w2"],
        "gate_w": _w((lambda *s: torch.randn(*s, dtype=torch.bfloat16) * 0.05)(576) * 16.0),
    }

def reference(A_x, A_c_kv, A_w_q, A_w_uk, A_w_uv, A_w_o, B_x, B_w1, B_w2, gate_w):
    def _A_ref(x, c_kv, w_q, w_uk, w_uv, w_o):
        B, Sq, M = x.shape[0], x.shape[1], x.shape[2]
        Sk = c_kv.shape[1]
        H, D = w_q.shape[1], w_q.shape[2]
        q = torch.einsum("bqm,mhd->bhqd", x, w_q)
        k = torch.einsum("bkc,chd->bhkd", c_kv, w_uk)
        v = torch.einsum("bkc,chd->bhkd", c_kv, w_uv)
        scores = torch.einsum("bhqd,bhkd->bhqk", q, k) * (D ** -0.5)
        off = Sk - Sq
        qi = torch.arange(Sq)[:, None]
        kj = torch.arange(Sk)[None, :]
        cmask = kj <= (qi + off)
        scores = torch.where(cmask[None, None], scores, -1e9)
        p = _softmax(scores, axis=-1)
        ctx = torch.einsum("bhqk,bhkd->bhqd", p, v)
        return torch.einsum("bhqd,hdm->bqm", ctx, w_o)

    def _B_ref(x, w1, w2):
        h = torch.einsum("bsd,df->bsf", x, w1)
        zero = torch.zeros_like(h)
        h = torch.maximum(h, zero)
        return torch.einsum("bsf,fd->bsd", h, w2)

    x = A_x
    g = _sigmoid((x * gate_w).sum(-1, keepdims=True))
    a = _A_ref(x, A_c_kv, A_w_q, A_w_uk, A_w_uv, A_w_o)
    b = _B_ref(x, B_w1, B_w2)
    return g * a + (1 - g) * b
```

```asm
; @launch kernel=k1_proj_kernel grid=(1088,1,1) block=(512,1,1) lds=147456
; @launch kernel=k2_attn_kernel grid=(512,1,1) block=(256,1,1) lds=65536
; @launch kernel=k3_out_kernel grid=(240,1,1) block=(256,1,1) lds=122880
; @launch kernel=k4_mix_kernel grid=(576,1,1) block=(256,1,1) lds=0
.amdgcn_target "amdgcn-amd-amdhsa--gfx950"
.text
.p2align 8
k1_proj_kernel:
    s_cmp_ge_u32 s2, 1088
    s_cbranch_scc1 Ldone_2
    s_cmp_ge_u32 s2, 1056
    s_cbranch_scc1 Lgate_1
    s_load_dwordx2 s[6:7], s[0:1], 96
    s_cmp_lt_u32 s2, 256
    s_cbranch_scc1 Lj_3
    s_cmp_lt_u32 s2, 512
    s_cbranch_scc1 Lj_4
    s_cmp_lt_u32 s2, 768
    s_cbranch_scc1 Lj_5
Lj_6:
    s_load_dwordx2 s[4:5], s[0:1], 0
    s_load_dwordx2 s[52:53], s[0:1], 56
    s_sub_u32 s50, s2, 768
    s_mul_i32 s51, s50, 1821
    s_lshr_b32 s51, s51, 16
    s_mul_i32 s28, s51, 36
    s_sub_u32 s50, s50, s28
    s_mov_b32 s20, 1152
    s_mov_b32 s21, 9216
    s_mov_b32 s22, 9
    s_mov_b32 s10, 2359296
    s_mov_b32 s14, 5308416
    s_mov_b32 s54, 50331648
    s_mov_b32 s55, 9216
    s_mov_b32 s56, 1
    s_branch Lj_7
Lj_3:
    s_load_dwordx2 s[4:5], s[0:1], 0
    s_load_dwordx2 s[52:53], s[0:1], 16
    s_and_b32 s50, s2, 31
    s_lshr_b32 s51, s2, 5
    s_mov_b32 s20, 1152
    s_mov_b32 s21, 8192
    s_mov_b32 s22, 9
    s_mov_b32 s10, 2359296
    s_mov_b32 s14, 4718592
    s_mov_b32 s54, 0
    s_mov_b32 s55, 8192
    s_mov_b32 s56, 0
    s_branch Lj_7
Lj_4:
    s_load_dwordx2 s[4:5], s[0:1], 8
    s_load_dwordx2 s[52:53], s[0:1], 24
    s_and_b32 s50, s2, 31
    s_bfe_u32 s51, s2, 0x30005
    s_mov_b32 s20, 1024
    s_mov_b32 s21, 8192
    s_mov_b32 s22, 8
    s_mov_b32 s10, 2097152
    s_mov_b32 s14, 4194304
    s_mov_b32 s54, 16777216
    s_mov_b32 s55, 8192
    s_mov_b32 s56, 0
    s_branch Lj_7
Lj_5:
    s_load_dwordx2 s[4:5], s[0:1], 8
    s_load_dwordx2 s[52:53], s[0:1], 32
    s_and_b32 s50, s2, 31
    s_bfe_u32 s51, s2, 0x30005
    s_mov_b32 s20, 1024
    s_mov_b32 s21, 8192
    s_mov_b32 s22, 8
    s_mov_b32 s10, 2097152
    s_mov_b32 s14, 4194304
    s_mov_b32 s54, 33554432
    s_mov_b32 s55, 4096
    s_mov_b32 s56, 2
Lj_7:
    s_waitcnt lgkmcnt(0)
    s_mov_b32 s8, s4
    s_and_b32 s9, s5, 0xffff
    s_mov_b32 s11, 0x20000
    s_mov_b32 s12, s52
    s_and_b32 s13, s53, 0xffff
    s_mov_b32 s15, 0x20000
    s_mov_b32 s16, s6
    s_and_b32 s17, s7, 0xffff
    s_mov_b32 s18, 268435456
    s_mov_b32 s19, 0x20000
    s_mul_i32 s23, s51, 256
    s_mul_i32 s23, s23, s20
    s_lshl_b32 s24, s50, 8
    v_lshrrev_b32 v1, 6, v0
    v_and_b32 v0, 63, v0
    s_nop 0
    v_readfirstlane_b32 s25, v1
    s_nop 3
    s_lshr_b32 s26, s25, 1
    s_and_b32 s27, s25, 1
    v_lshrrev_b32 v1, 3, v0
    v_mul_lo_u32 v8, v1, s20
    s_and_b32 s28, s25, 1
    s_lshl_b32 s28, s28, 2
    v_lshrrev_b32 v2, 4, v0
    v_add_u32 v2, s28, v2
    v_and_b32 v2, 7, v2
    v_and_b32 v3, 7, v0
    v_xor_b32 v2, v2, v3
    v_lshlrev_b32 v2, 4, v2
    v_add_u32 v8, v8, v2
    v_mul_lo_u32 v9, v1, s21
    v_bfe_u32 v2, v0, 2, 1
    v_bfe_u32 v3, v0, 4, 1
    v_xor_b32 v2, v2, v3
    v_lshlrev_b32 v2, 2, v2
    v_and_b32 v3, 3, v0
    v_or_b32 v2, v2, v3
    v_lshlrev_b32 v2, 4, v2
    v_add_u32 v9, v9, v2
    v_and_b32 v1, 31, v0
    v_lshlrev_b32 v1, 7, v1
    s_lshl_b32 s28, s26, 13
    v_add_u32 v1, s28, v1
    v_lshrrev_b32 v2, 5, v0
    v_bfe_u32 v3, v0, 1, 3
    v_xor_b32 v2, v2, v3
    v_xor_b32 v3, 0, v2
    v_lshlrev_b32 v3, 4, v3
    v_add_u32 v10, v1, v3
    v_xor_b32 v3, 2, v2
    v_lshlrev_b32 v3, 4, v3
    v_add_u32 v11, v1, v3
    v_xor_b32 v3, 4, v2
    v_lshlrev_b32 v3, 4, v3
    v_add_u32 v12, v1, v3
    v_xor_b32 v3, 6, v2
    v_lshlrev_b32 v3, 4, v3
    v_add_u32 v13, v1, v3
    v_bfe_u32 v1, v0, 2, 2
    v_lshrrev_b32 v2, 5, v0
    v_lshlrev_b32 v2, 3, v2
    v_add_u32 v2, v2, v1
    v_lshlrev_b32 v2, 7, v2
    v_bfe_u32 v3, v0, 4, 1
    v_lshlrev_b32 v3, 5, v3
    v_add_u32 v2, v2, v3
    v_and_b32 v3, 3, v0
    v_lshlrev_b32 v3, 3, v3
    v_add_u32 v2, v2, v3
    v_lshrrev_b32 v1, 1, v1
    s_mul_i32 s28, s27, 2
    s_add_u32 s28, s28, 0
    s_and_b32 s29, s28, 1
    s_lshr_b32 s28, s28, 1
    s_lshl_b32 s28, s28, 13
    s_add_u32 s28, s28, 32768
    v_xor_b32 v3, s29, v1
    v_lshlrev_b32 v3, 6, v3
    v_add_u32 v3, v2, v3
    v_add_u32 v4, s28, v3
    s_mul_i32 s28, s27, 2
    s_add_u32 s28, s28, 1
    s_and_b32 s29, s28, 1
    s_lshr_b32 s28, s28, 1
    s_lshl_b32 s28, s28, 13
    s_add_u32 s28, s28, 32768
    v_xor_b32 v3, s29, v1
    v_lshlrev_b32 v3, 6, v3
    v_add_u32 v3, v2, v3
    v_add_u32 v5, s28, v3
    s_mul_i32 s28, s25, s20
    s_lshl_b32 s28, s28, 3
    s_add_u32 s28, s28, s23
    s_mul_i32 s29, s20, 64
    s_mov_b32 s32, s28
    s_add_u32 s28, s28, s29
    s_mov_b32 s33, s28
    s_add_u32 s28, s28, s29
    s_mov_b32 s34, s28
    s_add_u32 s28, s28, s29
    s_mov_b32 s35, s28
    s_add_u32 s28, s25, 0
    s_and_b32 s29, s28, 7
    s_mul_i32 s29, s29, s21
    s_lshl_b32 s29, s29, 3
    s_lshr_b32 s28, s28, 3
    s_lshl_b32 s28, s28, 7
    s_add_u32 s28, s28, s29
    s_add_u32 s40, s28, s24
    s_add_u32 s28, s25, 8
    s_and_b32 s29, s28, 7
    s_mul_i32 s29, s29, s21
    s_lshl_b32 s29, s29, 3
    s_lshr_b32 s28, s28, 3
    s_lshl_b32 s28, s28, 7
    s_add_u32 s28, s28, s29
    s_add_u32 s41, s28, s24
    s_lshl_b32 s30, s21, 6
    s_lshl_b32 s31, s25, 10
    s_mov_b32 s64, 49152
    v_mov_b32 v48, 0
    v_mov_b32 v49, 0
    v_mov_b32 v50, 0
    v_mov_b32 v51, 0
    v_mov_b32 v52, 0
    v_mov_b32 v53, 0
    v_mov_b32 v54, 0
    v_mov_b32 v55, 0
    v_mov_b32 v56, 0
    v_mov_b32 v57, 0
    v_mov_b32 v58, 0
    v_mov_b32 v59, 0
    v_mov_b32 v60, 0
    v_mov_b32 v61, 0
    v_mov_b32 v62, 0
    v_mov_b32 v63, 0
    v_mov_b32 v64, 0
    v_mov_b32 v65, 0
    v_mov_b32 v66, 0
    v_mov_b32 v67, 0
    v_mov_b32 v68, 0
    v_mov_b32 v69, 0
    v_mov_b32 v70, 0
    v_mov_b32 v71, 0
    v_mov_b32 v72, 0
    v_mov_b32 v73, 0
    v_mov_b32 v74, 0
    v_mov_b32 v75, 0
    v_mov_b32 v76, 0
    v_mov_b32 v77, 0
    v_mov_b32 v78, 0
    v_mov_b32 v79, 0
    v_mov_b32 v80, 0
    v_mov_b32 v81, 0
    v_mov_b32 v82, 0
    v_mov_b32 v83, 0
    v_mov_b32 v84, 0
    v_mov_b32 v85, 0
    v_mov_b32 v86, 0
    v_mov_b32 v87, 0
    v_mov_b32 v88, 0
    v_mov_b32 v89, 0
    v_mov_b32 v90, 0
    v_mov_b32 v91, 0
    v_mov_b32 v92, 0
    v_mov_b32 v93, 0
    v_mov_b32 v94, 0
    v_mov_b32 v95, 0
    v_mov_b32 v96, 0
    v_mov_b32 v97, 0
    v_mov_b32 v98, 0
    v_mov_b32 v99, 0
    v_mov_b32 v100, 0
    v_mov_b32 v101, 0
    v_mov_b32 v102, 0
    v_mov_b32 v103, 0
    v_mov_b32 v104, 0
    v_mov_b32 v105, 0
    v_mov_b32 v106, 0
    v_mov_b32 v107, 0
    v_mov_b32 v108, 0
    v_mov_b32 v109, 0
    v_mov_b32 v110, 0
    v_mov_b32 v111, 0
    s_cmp_eq_u32 s56, 2
    s_cbranch_scc1 Ltr_8
    s_add_u32 m0, s31, 0
    s_nop 0
    buffer_load_dwordx4 v8, s[8:11], s32 offen lds
    s_add_u32 s32, s32, 128
    s_add_u32 m0, s31, 8192
    s_nop 0
    buffer_load_dwordx4 v8, s[8:11], s33 offen lds
    s_add_u32 s33, s33, 128
    s_add_u32 m0, s31, 16384
    s_nop 0
    buffer_load_dwordx4 v8, s[8:11], s34 offen lds
    s_add_u32 s34, s34, 128
    s_add_u32 m0, s31, 24576
    s_nop 0
    buffer_load_dwordx4 v8, s[8:11], s35 offen lds
    s_add_u32 s35, s35, 128
    s_add_u32 m0, s31, 32768
    s_nop 0
    buffer_load_dwordx4 v9, s[12:15], s40 offen lds
    s_add_u32 s40, s40, s30
    s_add_u32 m0, s31, 40960
    s_nop 0
    buffer_load_dwordx4 v9, s[12:15], s41 offen lds
    s_add_u32 s41, s41, s30
    s_add_u32 s31, s31, 49152
    s_add_u32 m0, s31, 0
    s_nop 0
    buffer_load_dwordx4 v8, s[8:11], s32 offen lds
    s_add_u32 s32, s32, 128
    s_add_u32 m0, s31, 8192
    s_nop 0
    buffer_load_dwordx4 v8, s[8:11], s33 offen lds
    s_add_u32 s33, s33, 128
    s_add_u32 m0, s31, 16384
    s_nop 0
    buffer_load_dwordx4 v8, s[8:11], s34 offen lds
    s_add_u32 s34, s34, 128
    s_add_u32 m0, s31, 24576
    s_nop 0
    buffer_load_dwordx4 v8, s[8:11], s35 offen lds
    s_add_u32 s35, s35, 128
    s_add_u32 m0, s31, 32768
    s_nop 0
    buffer_load_dwordx4 v9, s[12:15], s40 offen lds
    s_add_u32 s40, s40, s30
    s_add_u32 m0, s31, 40960
    s_nop 0
    buffer_load_dwordx4 v9, s[12:15], s41 offen lds
    s_add_u32 s41, s41, s30
    s_add_u32 s31, s31, 49152
    s_mov_b32 s48, 0
    s_mov_b32 s63, 0
    s_mov_b32 s60, 49152
    s_mov_b32 s61, -98304
Lk_10:
    s_add_u32 s49, s48, 1
    s_cmp_lt_u32 s49, s22
    s_cbranch_scc0 Lw0_11
    s_waitcnt vmcnt(6)
    s_branch Lwj_12
Lw0_11:
    s_waitcnt vmcnt(0)
Lwj_12:
    s_barrier
    s_add_u32 s49, s48, 2
    s_cmp_lt_u32 s49, s22
    s_cbranch_scc0 Lnd_13
    s_add_u32 m0, s31, 0
    s_nop 0
    buffer_load_dwordx4 v8, s[8:11], s32 offen lds
    s_add_u32 s32, s32, 128
    s_add_u32 m0, s31, 8192
    s_nop 0
    buffer_load_dwordx4 v8, s[8:11], s33 offen lds
    s_add_u32 s33, s33, 128
    s_add_u32 m0, s31, 16384
    s_nop 0
    buffer_load_dwordx4 v8, s[8:11], s34 offen lds
    s_add_u32 s34, s34, 128
    s_add_u32 m0, s31, 24576
    s_nop 0
    buffer_load_dwordx4 v8, s[8:11], s35 offen lds
    s_add_u32 s35, s35, 128
    s_add_u32 m0, s31, 32768
    s_nop 0
    buffer_load_dwordx4 v9, s[12:15], s40 offen lds
    s_add_u32 s40, s40, s30
    s_add_u32 m0, s31, 40960
    s_nop 0
    buffer_load_dwordx4 v9, s[12:15], s41 offen lds
    s_add_u32 s41, s41, s30
Lnd_13:
    ds_read_b128 v[16:19], v10 offset:0
    ds_read_b128 v[20:23], v10 offset:4096
    ds_read_b64_tr_b16 v[32:33], v4 offset:0
    ds_read_b64_tr_b16 v[34:35], v4 offset:512
    ds_read_b64_tr_b16 v[36:37], v5 offset:0
    ds_read_b64_tr_b16 v[38:39], v5 offset:512
    ds_read_b128 v[24:27], v11 offset:0
    ds_read_b128 v[28:31], v11 offset:4096
    ds_read_b64_tr_b16 v[40:41], v4 offset:2048
    ds_read_b64_tr_b16 v[42:43], v4 offset:2560
    ds_read_b64_tr_b16 v[44:45], v5 offset:2048
    ds_read_b64_tr_b16 v[46:47], v5 offset:2560
    s_waitcnt lgkmcnt(6)
    v_mfma_f32_32x32x16_bf16 v[48:63], v[32:35], v[16:19], v[48:63]
    v_mfma_f32_32x32x16_bf16 v[64:79], v[36:39], v[16:19], v[64:79]
    v_mfma_f32_32x32x16_bf16 v[80:95], v[32:35], v[20:23], v[80:95]
    v_mfma_f32_32x32x16_bf16 v[96:111], v[36:39], v[20:23], v[96:111]
    ds_read_b128 v[16:19], v12 offset:0
    ds_read_b128 v[20:23], v12 offset:4096
    ds_read_b64_tr_b16 v[32:33], v4 offset:4096
    ds_read_b64_tr_b16 v[34:35], v4 offset:4608
    ds_read_b64_tr_b16 v[36:37], v5 offset:4096
    ds_read_b64_tr_b16 v[38:39], v5 offset:4608
    s_waitcnt lgkmcnt(6)
    v_mfma_f32_32x32x16_bf16 v[48:63], v[40:43], v[24:27], v[48:63]
    v_mfma_f32_32x32x16_bf16 v[64:79], v[44:47], v[24:27], v[64:79]
    v_mfma_f32_32x32x16_bf16 v[80:95], v[40:43], v[28:31], v[80:95]
    v_mfma_f32_32x32x16_bf16 v[96:111], v[44:47], v[28:31], v[96:111]
    ds_read_b128 v[24:27], v13 offset:0
    ds_read_b128 v[28:31], v13 offset:4096
    ds_read_b64_tr_b16 v[40:41], v4 offset:6144
    ds_read_b64_tr_b16 v[42:43], v4 offset:6656
    ds_read_b64_tr_b16 v[44:45], v5 offset:6144
    ds_read_b64_tr_b16 v[46:47], v5 offset:6656
    s_waitcnt lgkmcnt(6)
    v_mfma_f32_32x32x16_bf16 v[48:63], v[32:35], v[16:19], v[48:63]
    v_mfma_f32_32x32x16_bf16 v[64:79], v[36:39], v[16:19], v[64:79]
    v_mfma_f32_32x32x16_bf16 v[80:95], v[32:35], v[20:23], v[80:95]
    v_mfma_f32_32x32x16_bf16 v[96:111], v[36:39], v[20:23], v[96:111]
    s_waitcnt lgkmcnt(0)
    v_mfma_f32_32x32x16_bf16 v[48:63], v[40:43], v[24:27], v[48:63]
    v_mfma_f32_32x32x16_bf16 v[64:79], v[44:47], v[24:27], v[64:79]
    v_mfma_f32_32x32x16_bf16 v[80:95], v[40:43], v[28:31], v[80:95]
    v_mfma_f32_32x32x16_bf16 v[96:111], v[44:47], v[28:31], v[96:111]
    s_cmp_eq_u32 s63, 2
    s_cselect_b32 s64, s61, s60
    s_cselect_b32 s62, -1, s63
    s_add_u32 s63, s62, 1
    v_add_u32 v10, s64, v10
    v_add_u32 v11, s64, v11
    v_add_u32 v12, s64, v12
    v_add_u32 v13, s64, v13
    v_add_u32 v4, s64, v4
    v_add_u32 v5, s64, v5
    s_cmp_eq_u32 s63, 1
    s_cselect_b32 s64, s61, s60
    s_add_u32 s31, s31, s64
    s_add_u32 s48, s48, 1
    s_cmp_lt_u32 s48, s22
    s_cbranch_scc1 Lk_10
    s_nop 7
    s_nop 7
    s_mul_i32 s28, s51, 256
    s_mul_i32 s28, s28, s55
    s_add_u32 s28, s28, s54
    s_lshl_b32 s29, s50, 8
    s_add_u32 s28, s28, s29
    s_lshl_b32 s29, s55, 5
    s_add_u32 s29, s28, s29
    v_and_b32 v1, 31, v0
    v_mul_lo_u32 v1, v1, s55
    v_lshrrev_b32 v2, 5, v0
    v_lshlrev_b32 v2, 4, v2
    v_add_u32 v1, v1, v2
    s_mul_i32 s57, s26, s55
    s_lshl_b32 s57, s57, 6
    s_lshl_b32 s58, s27, 7
    s_add_u32 s57, s57, s58
    v_add_u32 v1, s57, v1
    s_cmp_eq_u32 s56, 1
    s_cbranch_scc0 Lnorelu_14
    v_max_f32 v48, 0, v48
    v_max_f32 v49, 0, v49
    v_max_f32 v50, 0, v50
    v_max_f32 v51, 0, v51
    v_max_f32 v52, 0, v52
    v_max_f32 v53, 0, v53
    v_max_f32 v54, 0, v54
    v_max_f32 v55, 0, v55
    v_max_f32 v56, 0, v56
    v_max_f32 v57, 0, v57
    v_max_f32 v58, 0, v58
    v_max_f32 v59, 0, v59
    v_max_f32 v60, 0, v60
    v_max_f32 v61, 0, v61
    v_max_f32 v62, 0, v62
    v_max_f32 v63, 0, v63
    v_max_f32 v64, 0, v64
    v_max_f32 v65, 0, v65
    v_max_f32 v66, 0, v66
    v_max_f32 v67, 0, v67
    v_max_f32 v68, 0, v68
    v_max_f32 v69, 0, v69
    v_max_f32 v70, 0, v70
    v_max_f32 v71, 0, v71
    v_max_f32 v72, 0, v72
    v_max_f32 v73, 0, v73
    v_max_f32 v74, 0, v74
    v_max_f32 v75, 0, v75
    v_max_f32 v76, 0, v76
    v_max_f32 v77, 0, v77
    v_max_f32 v78, 0, v78
    v_max_f32 v79, 0, v79
    v_max_f32 v80, 0, v80
    v_max_f32 v81, 0, v81
    v_max_f32 v82, 0, v82
    v_max_f32 v83, 0, v83
    v_max_f32 v84, 0, v84
    v_max_f32 v85, 0, v85
    v_max_f32 v86, 0, v86
    v_max_f32 v87, 0, v87
    v_max_f32 v88, 0, v88
    v_max_f32 v89, 0, v89
    v_max_f32 v90, 0, v90
    v_max_f32 v91, 0, v91
    v_max_f32 v92, 0, v92
    v_max_f32 v93, 0, v93
    v_max_f32 v94, 0, v94
    v_max_f32 v95, 0, v95
    v_max_f32 v96, 0, v96
    v_max_f32 v97, 0, v97
    v_max_f32 v98, 0, v98
    v_max_f32 v99, 0, v99
    v_max_f32 v100, 0, v100
    v_max_f32 v101, 0, v101
    v_max_f32 v102, 0, v102
    v_max_f32 v103, 0, v103
    v_max_f32 v104, 0, v104
    v_max_f32 v105, 0, v105
    v_max_f32 v106, 0, v106
    v_max_f32 v107, 0, v107
    v_max_f32 v108, 0, v108
    v_max_f32 v109, 0, v109
    v_max_f32 v110, 0, v110
    v_max_f32 v111, 0, v111
Lnorelu_14:
    v_cvt_pk_bf16_f32 v16, v48, v49
    v_cvt_pk_bf16_f32 v17, v50, v51
    v_cvt_pk_bf16_f32 v18, v52, v53
    v_cvt_pk_bf16_f32 v19, v54, v55
    buffer_store_dwordx4 v[16:19], v1, s[16:19], s28 offen offset:0
    s_nop 1
    v_cvt_pk_bf16_f32 v16, v56, v57
    v_cvt_pk_bf16_f32 v17, v58, v59
    v_cvt_pk_bf16_f32 v18, v60, v61
    v_cvt_pk_bf16_f32 v19, v62, v63
    buffer_store_dwordx4 v[16:19], v1, s[16:19], s28 offen offset:32
    s_nop 1
    v_cvt_pk_bf16_f32 v16, v64, v65
    v_cvt_pk_bf16_f32 v17, v66, v67
    v_cvt_pk_bf16_f32 v18, v68, v69
    v_cvt_pk_bf16_f32 v19, v70, v71
    buffer_store_dwordx4 v[16:19], v1, s[16:19], s28 offen offset:64
    s_nop 1
    v_cvt_pk_bf16_f32 v16, v72, v73
    v_cvt_pk_bf16_f32 v17, v74, v75
    v_cvt_pk_bf16_f32 v18, v76, v77
    v_cvt_pk_bf16_f32 v19, v78, v79
    buffer_store_dwordx4 v[16:19], v1, s[16:19], s28 offen offset:96
    s_nop 1
    v_cvt_pk_bf16_f32 v16, v80, v81
    v_cvt_pk_bf16_f32 v17, v82, v83
    v_cvt_pk_bf16_f32 v18, v84, v85
    v_cvt_pk_bf16_f32 v19, v86, v87
    buffer_store_dwordx4 v[16:19], v1, s[16:19], s29 offen offset:0
    s_nop 1
    v_cvt_pk_bf16_f32 v16, v88, v89
    v_cvt_pk_bf16_f32 v17, v90, v91
    v_cvt_pk_bf16_f32 v18, v92, v93
    v_cvt_pk_bf16_f32 v19, v94, v95
    buffer_store_dwordx4 v[16:19], v1, s[16:19], s29 offen offset:32
    s_nop 1
    v_cvt_pk_bf16_f32 v16, v96, v97
    v_cvt_pk_bf16_f32 v17, v98, v99
    v_cvt_pk_bf16_f32 v18, v100, v101
    v_cvt_pk_bf16_f32 v19, v102, v103
    buffer_store_dwordx4 v[16:19], v1, s[16:19], s29 offen offset:64
    s_nop 1
    v_cvt_pk_bf16_f32 v16, v104, v105
    v_cvt_pk_bf16_f32 v17, v106, v107
    v_cvt_pk_bf16_f32 v18, v108, v109
    v_cvt_pk_bf16_f32 v19, v110, v111
    buffer_store_dwordx4 v[16:19], v1, s[16:19], s29 offen offset:96
    s_nop 1
    s_branch Ldone_2
Ltr_8:
    s_add_u32 m0, s31, 0
    s_nop 0
    buffer_load_dwordx4 v8, s[8:11], s32 offen lds
    s_add_u32 s32, s32, 128
    s_add_u32 m0, s31, 8192
    s_nop 0
    buffer_load_dwordx4 v8, s[8:11], s33 offen lds
    s_add_u32 s33, s33, 128
    s_add_u32 m0, s31, 16384
    s_nop 0
    buffer_load_dwordx4 v8, s[8:11], s34 offen lds
    s_add_u32 s34, s34, 128
    s_add_u32 m0, s31, 24576
    s_nop 0
    buffer_load_dwordx4 v8, s[8:11], s35 offen lds
    s_add_u32 s35, s35, 128
    s_add_u32 m0, s31, 32768
    s_nop 0
    buffer_load_dwordx4 v9, s[12:15], s40 offen lds
    s_add_u32 s40, s40, s30
    s_add_u32 m0, s31, 40960
    s_nop 0
    buffer_load_dwordx4 v9, s[12:15], s41 offen lds
    s_add_u32 s41, s41, s30
    s_add_u32 s31, s31, 49152
    s_add_u32 m0, s31, 0
    s_nop 0
    buffer_load_dwordx4 v8, s[8:11], s32 offen lds
    s_add_u32 s32, s32, 128
    s_add_u32 m0, s31, 8192
    s_nop 0
    buffer_load_dwordx4 v8, s[8:11], s33 offen lds
    s_add_u32 s33, s33, 128
    s_add_u32 m0, s31, 16384
    s_nop 0
    buffer_load_dwordx4 v8, s[8:11], s34 offen lds
    s_add_u32 s34, s34, 128
    s_add_u32 m0, s31, 24576
    s_nop 0
    buffer_load_dwordx4 v8, s[8:11], s35 offen lds
    s_add_u32 s35, s35, 128
    s_add_u32 m0, s31, 32768
    s_nop 0
    buffer_load_dwordx4 v9, s[12:15], s40 offen lds
    s_add_u32 s40, s40, s30
    s_add_u32 m0, s31, 40960
    s_nop 0
    buffer_load_dwordx4 v9, s[12:15], s41 offen lds
    s_add_u32 s41, s41, s30
    s_add_u32 s31, s31, 49152
    s_mov_b32 s48, 0
    s_mov_b32 s63, 0
    s_mov_b32 s60, 49152
    s_mov_b32 s61, -98304
Lk_15:
    s_add_u32 s49, s48, 1
    s_cmp_lt_u32 s49, s22
    s_cbranch_scc0 Lw0_16
    s_waitcnt vmcnt(6)
    s_branch Lwj_17
Lw0_16:
    s_waitcnt vmcnt(0)
Lwj_17:
    s_barrier
    s_add_u32 s49, s48, 2
    s_cmp_lt_u32 s49, s22
    s_cbranch_scc0 Lnd_18
    s_add_u32 m0, s31, 0
    s_nop 0
    buffer_load_dwordx4 v8, s[8:11], s32 offen lds
    s_add_u32 s32, s32, 128
    s_add_u32 m0, s31, 8192
    s_nop 0
    buffer_load_dwordx4 v8, s[8:11], s33 offen lds
    s_add_u32 s33, s33, 128
    s_add_u32 m0, s31, 16384
    s_nop 0
    buffer_load_dwordx4 v8, s[8:11], s34 offen lds
    s_add_u32 s34, s34, 128
    s_add_u32 m0, s31, 24576
    s_nop 0
    buffer_load_dwordx4 v8, s[8:11], s35 offen lds
    s_add_u32 s35, s35, 128
    s_add_u32 m0, s31, 32768
    s_nop 0
    buffer_load_dwordx4 v9, s[12:15], s40 offen lds
    s_add_u32 s40, s40, s30
    s_add_u32 m0, s31, 40960
    s_nop 0
    buffer_load_dwordx4 v9, s[12:15], s41 offen lds
    s_add_u32 s41, s41, s30
Lnd_18:
    ds_read_b128 v[16:19], v10 offset:0
    ds_read_b128 v[20:23], v10 offset:4096
    ds_read_b64_tr_b16 v[32:33], v4 offset:0
    ds_read_b64_tr_b16 v[34:35], v4 offset:512
    ds_read_b64_tr_b16 v[36:37], v5 offset:0
    ds_read_b64_tr_b16 v[38:39], v5 offset:512
    ds_read_b128 v[24:27], v11 offset:0
    ds_read_b128 v[28:31], v11 offset:4096
    ds_read_b64_tr_b16 v[40:41], v4 offset:2048
    ds_read_b64_tr_b16 v[42:43], v4 offset:2560
    ds_read_b64_tr_b16 v[44:45], v5 offset:2048
    ds_read_b64_tr_b16 v[46:47], v5 offset:2560
    s_waitcnt lgkmcnt(6)
    v_mfma_f32_32x32x16_bf16 v[48:63], v[16:19], v[32:35], v[48:63]
    v_mfma_f32_32x32x16_bf16 v[64:79], v[16:19], v[36:39], v[64:79]
    v_mfma_f32_32x32x16_bf16 v[80:95], v[20:23], v[32:35], v[80:95]
    v_mfma_f32_32x32x16_bf16 v[96:111], v[20:23], v[36:39], v[96:111]
    ds_read_b128 v[16:19], v12 offset:0
    ds_read_b128 v[20:23], v12 offset:4096
    ds_read_b64_tr_b16 v[32:33], v4 offset:4096
    ds_read_b64_tr_b16 v[34:35], v4 offset:4608
    ds_read_b64_tr_b16 v[36:37], v5 offset:4096
    ds_read_b64_tr_b16 v[38:39], v5 offset:4608
    s_waitcnt lgkmcnt(6)
    v_mfma_f32_32x32x16_bf16 v[48:63], v[24:27], v[40:43], v[48:63]
    v_mfma_f32_32x32x16_bf16 v[64:79], v[24:27], v[44:47], v[64:79]
    v_mfma_f32_32x32x16_bf16 v[80:95], v[28:31], v[40:43], v[80:95]
    v_mfma_f32_32x32x16_bf16 v[96:111], v[28:31], v[44:47], v[96:111]
    ds_read_b128 v[24:27], v13 offset:0
    ds_read_b128 v[28:31], v13 offset:4096
    ds_read_b64_tr_b16 v[40:41], v4 offset:6144
    ds_read_b64_tr_b16 v[42:43], v4 offset:6656
    ds_read_b64_tr_b16 v[44:45], v5 offset:6144
    ds_read_b64_tr_b16 v[46:47], v5 offset:6656
    s_waitcnt lgkmcnt(6)
    v_mfma_f32_32x32x16_bf16 v[48:63], v[16:19], v[32:35], v[48:63]
    v_mfma_f32_32x32x16_bf16 v[64:79], v[16:19], v[36:39], v[64:79]
    v_mfma_f32_32x32x16_bf16 v[80:95], v[20:23], v[32:35], v[80:95]
    v_mfma_f32_32x32x16_bf16 v[96:111], v[20:23], v[36:39], v[96:111]
    s_waitcnt lgkmcnt(0)
    v_mfma_f32_32x32x16_bf16 v[48:63], v[24:27], v[40:43], v[48:63]
    v_mfma_f32_32x32x16_bf16 v[64:79], v[24:27], v[44:47], v[64:79]
    v_mfma_f32_32x32x16_bf16 v[80:95], v[28:31], v[40:43], v[80:95]
    v_mfma_f32_32x32x16_bf16 v[96:111], v[28:31], v[44:47], v[96:111]
    s_cmp_eq_u32 s63, 2
    s_cselect_b32 s64, s61, s60
    s_cselect_b32 s62, -1, s63
    s_add_u32 s63, s62, 1
    v_add_u32 v10, s64, v10
    v_add_u32 v11, s64, v11
    v_add_u32 v12, s64, v12
    v_add_u32 v13, s64, v13
    v_add_u32 v4, s64, v4
    v_add_u32 v5, s64, v5
    s_cmp_eq_u32 s63, 1
    s_cselect_b32 s64, s61, s60
    s_add_u32 s31, s31, s64
    s_add_u32 s48, s48, 1
    s_cmp_lt_u32 s48, s22
    s_cbranch_scc1 Lk_15
    s_nop 7
    s_nop 7
    s_mul_i32 s28, s50, 128
    s_mul_i32 s28, s28, s55
    s_add_u32 s28, s28, s54
    s_mul_i32 s29, s51, 512
    s_add_u32 s28, s28, s29
    s_lshl_b32 s29, s55, 5
    s_add_u32 s29, s28, s29
    v_and_b32 v1, 31, v0
    v_mul_lo_u32 v1, v1, s55
    v_lshrrev_b32 v2, 5, v0
    v_lshlrev_b32 v2, 4, v2
    v_add_u32 v1, v1, v2
    s_mul_i32 s57, s27, s55
    s_lshl_b32 s57, s57, 6
    s_lshl_b32 s58, s26, 7
    s_add_u32 s57, s57, s58
    v_add_u32 v1, s57, v1
    v_cvt_pk_bf16_f32 v16, v48, v49
    v_cvt_pk_bf16_f32 v17, v50, v51
    v_cvt_pk_bf16_f32 v18, v52, v53
    v_cvt_pk_bf16_f32 v19, v54, v55
    buffer_store_dwordx4 v[16:19], v1, s[16:19], s28 offen offset:0
    s_nop 1
    v_cvt_pk_bf16_f32 v16, v56, v57
    v_cvt_pk_bf16_f32 v17, v58, v59
    v_cvt_pk_bf16_f32 v18, v60, v61
    v_cvt_pk_bf16_f32 v19, v62, v63
    buffer_store_dwordx4 v[16:19], v1, s[16:19], s28 offen offset:32
    s_nop 1
    v_cvt_pk_bf16_f32 v16, v64, v65
    v_cvt_pk_bf16_f32 v17, v66, v67
    v_cvt_pk_bf16_f32 v18, v68, v69
    v_cvt_pk_bf16_f32 v19, v70, v71
    buffer_store_dwordx4 v[16:19], v1, s[16:19], s29 offen offset:0
    s_nop 1
    v_cvt_pk_bf16_f32 v16, v72, v73
    v_cvt_pk_bf16_f32 v17, v74, v75
    v_cvt_pk_bf16_f32 v18, v76, v77
    v_cvt_pk_bf16_f32 v19, v78, v79
    buffer_store_dwordx4 v[16:19], v1, s[16:19], s29 offen offset:32
    s_nop 1
    v_cvt_pk_bf16_f32 v16, v80, v81
    v_cvt_pk_bf16_f32 v17, v82, v83
    v_cvt_pk_bf16_f32 v18, v84, v85
    v_cvt_pk_bf16_f32 v19, v86, v87
    buffer_store_dwordx4 v[16:19], v1, s[16:19], s28 offen offset:64
    s_nop 1
    v_cvt_pk_bf16_f32 v16, v88, v89
    v_cvt_pk_bf16_f32 v17, v90, v91
    v_cvt_pk_bf16_f32 v18, v92, v93
    v_cvt_pk_bf16_f32 v19, v94, v95
    buffer_store_dwordx4 v[16:19], v1, s[16:19], s28 offen offset:96
    s_nop 1
    v_cvt_pk_bf16_f32 v16, v96, v97
    v_cvt_pk_bf16_f32 v17, v98, v99
    v_cvt_pk_bf16_f32 v18, v100, v101
    v_cvt_pk_bf16_f32 v19, v102, v103
    buffer_store_dwordx4 v[16:19], v1, s[16:19], s29 offen offset:64
    s_nop 1
    v_cvt_pk_bf16_f32 v16, v104, v105
    v_cvt_pk_bf16_f32 v17, v106, v107
    v_cvt_pk_bf16_f32 v18, v108, v109
    v_cvt_pk_bf16_f32 v19, v110, v111
    buffer_store_dwordx4 v[16:19], v1, s[16:19], s29 offen offset:96
    s_nop 1
    s_branch Ldone_2
Lgate_1:
    s_load_dwordx2 s[4:5], s[0:1], 0
    s_load_dwordx2 s[52:53], s[0:1], 72
    s_load_dwordx2 s[6:7], s[0:1], 96
    s_waitcnt lgkmcnt(0)
    s_mov_b32 s8, s4
    s_and_b32 s9, s5, 0xffff
    s_mov_b32 s10, 2359296
    s_mov_b32 s11, 0x20000
    s_mov_b32 s12, s52
    s_and_b32 s13, s53, 0xffff
    s_mov_b32 s14, 1152
    s_mov_b32 s15, 0x20000
    s_mov_b32 s16, s6
    s_and_b32 s17, s7, 0xffff
    s_mov_b32 s18, 268435456
    s_mov_b32 s19, 0x20000
    s_sub_u32 s28, s2, 1056
    s_lshl_b32 s28, s28, 6
    v_lshrrev_b32 v1, 3, v0
    v_add_u32 v1, s28, v1
    v_mul_u32_u24 v2, 1152, v1
    v_and_b32 v3, 7, v0
    v_lshlrev_b32 v3, 4, v3
    v_add_u32 v2, v2, v3
    buffer_load_dwordx4 v[16:19], v2, s[8:11], 0 offen offset:0
    buffer_load_dwordx4 v[56:59], v3, s[12:15], 0 offen offset:0
    buffer_load_dwordx4 v[20:23], v2, s[8:11], 0 offen offset:128
    buffer_load_dwordx4 v[60:63], v3, s[12:15], 0 offen offset:128
    buffer_load_dwordx4 v[24:27], v2, s[8:11], 0 offen offset:256
    buffer_load_dwordx4 v[64:67], v3, s[12:15], 0 offen offset:256
    buffer_load_dwordx4 v[28:31], v2, s[8:11], 0 offen offset:384
    buffer_load_dwordx4 v[68:71], v3, s[12:15], 0 offen offset:384
    buffer_load_dwordx4 v[32:35], v2, s[8:11], 0 offen offset:512
    buffer_load_dwordx4 v[72:75], v3, s[12:15], 0 offen offset:512
    buffer_load_dwordx4 v[36:39], v2, s[8:11], 0 offen offset:640
    buffer_load_dwordx4 v[76:79], v3, s[12:15], 0 offen offset:640
    buffer_load_dwordx4 v[40:43], v2, s[8:11], 0 offen offset:768
    buffer_load_dwordx4 v[80:83], v3, s[12:15], 0 offen offset:768
    buffer_load_dwordx4 v[44:47], v2, s[8:11], 0 offen offset:896
    buffer_load_dwordx4 v[84:87], v3, s[12:15], 0 offen offset:896
    buffer_load_dwordx4 v[48:51], v2, s[8:11], 0 offen offset:1024
    buffer_load_dwordx4 v[88:91], v3, s[12:15], 0 offen offset:1024
    s_waitcnt vmcnt(0)
    v_mov_b32 v4, 0
    v_lshlrev_b32 v5, 16, v16
    v_lshlrev_b32 v6, 16, v56
    v_mul_f32 v5, v5, v6
    v_and_b32 v7, 0xffff0000, v16
    v_and_b32 v6, 0xffff0000, v56
    v_mul_f32 v7, v7, v6
    v_cvt_pk_bf16_f32 v5, v5, v7
    v_lshlrev_b32 v6, 16, v5
    v_and_b32 v5, 0xffff0000, v5
    v_add_f32 v4, v4, v6
    v_add_f32 v4, v4, v5
    v_lshlrev_b32 v5, 16, v17
    v_lshlrev_b32 v6, 16, v57
    v_mul_f32 v5, v5, v6
    v_and_b32 v7, 0xffff0000, v17
    v_and_b32 v6, 0xffff0000, v57
    v_mul_f32 v7, v7, v6
    v_cvt_pk_bf16_f32 v5, v5, v7
    v_lshlrev_b32 v6, 16, v5
    v_and_b32 v5, 0xffff0000, v5
    v_add_f32 v4, v4, v6
    v_add_f32 v4, v4, v5
    v_lshlrev_b32 v5, 16, v18
    v_lshlrev_b32 v6, 16, v58
    v_mul_f32 v5, v5, v6
    v_and_b32 v7, 0xffff0000, v18
    v_and_b32 v6, 0xffff0000, v58
    v_mul_f32 v7, v7, v6
    v_cvt_pk_bf16_f32 v5, v5, v7
    v_lshlrev_b32 v6, 16, v5
    v_and_b32 v5, 0xffff0000, v5
    v_add_f32 v4, v4, v6
    v_add_f32 v4, v4, v5
    v_lshlrev_b32 v5, 16, v19
    v_lshlrev_b32 v6, 16, v59
    v_mul_f32 v5, v5, v6
    v_and_b32 v7, 0xffff0000, v19
    v_and_b32 v6, 0xffff0000, v59
    v_mul_f32 v7, v7, v6
    v_cvt_pk_bf16_f32 v5, v5, v7
    v_lshlrev_b32 v6, 16, v5
    v_and_b32 v5, 0xffff0000, v5
    v_add_f32 v4, v4, v6
    v_add_f32 v4, v4, v5
    v_lshlrev_b32 v5, 16, v20
    v_lshlrev_b32 v6, 16, v60
    v_mul_f32 v5, v5, v6
    v_and_b32 v7, 0xffff0000, v20
    v_and_b32 v6, 0xffff0000, v60
    v_mul_f32 v7, v7, v6
    v_cvt_pk_bf16_f32 v5, v5, v7
    v_lshlrev_b32 v6, 16, v5
    v_and_b32 v5, 0xffff0000, v5
    v_add_f32 v4, v4, v6
    v_add_f32 v4, v4, v5
    v_lshlrev_b32 v5, 16, v21
    v_lshlrev_b32 v6, 16, v61
    v_mul_f32 v5, v5, v6
    v_and_b32 v7, 0xffff0000, v21
    v_and_b32 v6, 0xffff0000, v61
    v_mul_f32 v7, v7, v6
    v_cvt_pk_bf16_f32 v5, v5, v7
    v_lshlrev_b32 v6, 16, v5
    v_and_b32 v5, 0xffff0000, v5
    v_add_f32 v4, v4, v6
    v_add_f32 v4, v4, v5
    v_lshlrev_b32 v5, 16, v22
    v_lshlrev_b32 v6, 16, v62
    v_mul_f32 v5, v5, v6
    v_and_b32 v7, 0xffff0000, v22
    v_and_b32 v6, 0xffff0000, v62
    v_mul_f32 v7, v7, v6
    v_cvt_pk_bf16_f32 v5, v5, v7
    v_lshlrev_b32 v6, 16, v5
    v_and_b32 v5, 0xffff0000, v5
    v_add_f32 v4, v4, v6
    v_add_f32 v4, v4, v5
    v_lshlrev_b32 v5, 16, v23
    v_lshlrev_b32 v6, 16, v63
    v_mul_f32 v5, v5, v6
    v_and_b32 v7, 0xffff0000, v23
    v_and_b32 v6, 0xffff0000, v63
    v_mul_f32 v7, v7, v6
    v_cvt_pk_bf16_f32 v5, v5, v7
    v_lshlrev_b32 v6, 16, v5
    v_and_b32 v5, 0xffff0000, v5
    v_add_f32 v4, v4, v6
    v_add_f32 v4, v4, v5
    v_lshlrev_b32 v5, 16, v24
    v_lshlrev_b32 v6, 16, v64
    v_mul_f32 v5, v5, v6
    v_and_b32 v7, 0xffff0000, v24
    v_and_b32 v6, 0xffff0000, v64
    v_mul_f32 v7, v7, v6
    v_cvt_pk_bf16_f32 v5, v5, v7
    v_lshlrev_b32 v6, 16, v5
    v_and_b32 v5, 0xffff0000, v5
    v_add_f32 v4, v4, v6
    v_add_f32 v4, v4, v5
    v_lshlrev_b32 v5, 16, v25
    v_lshlrev_b32 v6, 16, v65
    v_mul_f32 v5, v5, v6
    v_and_b32 v7, 0xffff0000, v25
    v_and_b32 v6, 0xffff0000, v65
    v_mul_f32 v7, v7, v6
    v_cvt_pk_bf16_f32 v5, v5, v7
    v_lshlrev_b32 v6, 16, v5
    v_and_b32 v5, 0xffff0000, v5
    v_add_f32 v4, v4, v6
    v_add_f32 v4, v4, v5
    v_lshlrev_b32 v5, 16, v26
    v_lshlrev_b32 v6, 16, v66
    v_mul_f32 v5, v5, v6
    v_and_b32 v7, 0xffff0000, v26
    v_and_b32 v6, 0xffff0000, v66
    v_mul_f32 v7, v7, v6
    v_cvt_pk_bf16_f32 v5, v5, v7
    v_lshlrev_b32 v6, 16, v5
    v_and_b32 v5, 0xffff0000, v5
    v_add_f32 v4, v4, v6
    v_add_f32 v4, v4, v5
    v_lshlrev_b32 v5, 16, v27
    v_lshlrev_b32 v6, 16, v67
    v_mul_f32 v5, v5, v6
    v_and_b32 v7, 0xffff0000, v27
    v_and_b32 v6, 0xffff0000, v67
    v_mul_f32 v7, v7, v6
    v_cvt_pk_bf16_f32 v5, v5, v7
    v_lshlrev_b32 v6, 16, v5
    v_and_b32 v5, 0xffff0000, v5
    v_add_f32 v4, v4, v6
    v_add_f32 v4, v4, v5
    v_lshlrev_b32 v5, 16, v28
    v_lshlrev_b32 v6, 16, v68
    v_mul_f32 v5, v5, v6
    v_and_b32 v7, 0xffff0000, v28
    v_and_b32 v6, 0xffff0000, v68
    v_mul_f32 v7, v7, v6
    v_cvt_pk_bf16_f32 v5, v5, v7
    v_lshlrev_b32 v6, 16, v5
    v_and_b32 v5, 0xffff0000, v5
    v_add_f32 v4, v4, v6
    v_add_f32 v4, v4, v5
    v_lshlrev_b32 v5, 16, v29
    v_lshlrev_b32 v6, 16, v69
    v_mul_f32 v5, v5, v6
    v_and_b32 v7, 0xffff0000, v29
    v_and_b32 v6, 0xffff0000, v69
    v_mul_f32 v7, v7, v6
    v_cvt_pk_bf16_f32 v5, v5, v7
    v_lshlrev_b32 v6, 16, v5
    v_and_b32 v5, 0xffff0000, v5
    v_add_f32 v4, v4, v6
    v_add_f32 v4, v4, v5
    v_lshlrev_b32 v5, 16, v30
    v_lshlrev_b32 v6, 16, v70
    v_mul_f32 v5, v5, v6
    v_and_b32 v7, 0xffff0000, v30
    v_and_b32 v6, 0xffff0000, v70
    v_mul_f32 v7, v7, v6
    v_cvt_pk_bf16_f32 v5, v5, v7
    v_lshlrev_b32 v6, 16, v5
    v_and_b32 v5, 0xffff0000, v5
    v_add_f32 v4, v4, v6
    v_add_f32 v4, v4, v5
    v_lshlrev_b32 v5, 16, v31
    v_lshlrev_b32 v6, 16, v71
    v_mul_f32 v5, v5, v6
    v_and_b32 v7, 0xffff0000, v31
    v_and_b32 v6, 0xffff0000, v71
    v_mul_f32 v7, v7, v6
    v_cvt_pk_bf16_f32 v5, v5, v7
    v_lshlrev_b32 v6, 16, v5
    v_and_b32 v5, 0xffff0000, v5
    v_add_f32 v4, v4, v6
    v_add_f32 v4, v4, v5
    v_lshlrev_b32 v5, 16, v32
    v_lshlrev_b32 v6, 16, v72
    v_mul_f32 v5, v5, v6
    v_and_b32 v7, 0xffff0000, v32
    v_and_b32 v6, 0xffff0000, v72
    v_mul_f32 v7, v7, v6
    v_cvt_pk_bf16_f32 v5, v5, v7
    v_lshlrev_b32 v6, 16, v5
    v_and_b32 v5, 0xffff0000, v5
    v_add_f32 v4, v4, v6
    v_add_f32 v4, v4, v5
    v_lshlrev_b32 v5, 16, v33
    v_lshlrev_b32 v6, 16, v73
    v_mul_f32 v5, v5, v6
    v_and_b32 v7, 0xffff0000, v33
    v_and_b32 v6, 0xffff0000, v73
    v_mul_f32 v7, v7, v6
    v_cvt_pk_bf16_f32 v5, v5, v7
    v_lshlrev_b32 v6, 16, v5
    v_and_b32 v5, 0xffff0000, v5
    v_add_f32 v4, v4, v6
    v_add_f32 v4, v4, v5
    v_lshlrev_b32 v5, 16, v34
    v_lshlrev_b32 v6, 16, v74
    v_mul_f32 v5, v5, v6
    v_and_b32 v7, 0xffff0000, v34
    v_and_b32 v6, 0xffff0000, v74
    v_mul_f32 v7, v7, v6
    v_cvt_pk_bf16_f32 v5, v5, v7
    v_lshlrev_b32 v6, 16, v5
    v_and_b32 v5, 0xffff0000, v5
    v_add_f32 v4, v4, v6
    v_add_f32 v4, v4, v5
    v_lshlrev_b32 v5, 16, v35
    v_lshlrev_b32 v6, 16, v75
    v_mul_f32 v5, v5, v6
    v_and_b32 v7, 0xffff0000, v35
    v_and_b32 v6, 0xffff0000, v75
    v_mul_f32 v7, v7, v6
    v_cvt_pk_bf16_f32 v5, v5, v7
    v_lshlrev_b32 v6, 16, v5
    v_and_b32 v5, 0xffff0000, v5
    v_add_f32 v4, v4, v6
    v_add_f32 v4, v4, v5
    v_lshlrev_b32 v5, 16, v36
    v_lshlrev_b32 v6, 16, v76
    v_mul_f32 v5, v5, v6
    v_and_b32 v7, 0xffff0000, v36
    v_and_b32 v6, 0xffff0000, v76
    v_mul_f32 v7, v7, v6
    v_cvt_pk_bf16_f32 v5, v5, v7
    v_lshlrev_b32 v6, 16, v5
    v_and_b32 v5, 0xffff0000, v5
    v_add_f32 v4, v4, v6
    v_add_f32 v4, v4, v5
    v_lshlrev_b32 v5, 16, v37
    v_lshlrev_b32 v6, 16, v77
    v_mul_f32 v5, v5, v6
    v_and_b32 v7, 0xffff0000, v37
    v_and_b32 v6, 0xffff0000, v77
    v_mul_f32 v7, v7, v6
    v_cvt_pk_bf16_f32 v5, v5, v7
    v_lshlrev_b32 v6, 16, v5
    v_and_b32 v5, 0xffff0000, v5
    v_add_f32 v4, v4, v6
    v_add_f32 v4, v4, v5
    v_lshlrev_b32 v5, 16, v38
    v_lshlrev_b32 v6, 16, v78
    v_mul_f32 v5, v5, v6
    v_and_b32 v7, 0xffff0000, v38
    v_and_b32 v6, 0xffff0000, v78
    v_mul_f32 v7, v7, v6
    v_cvt_pk_bf16_f32 v5, v5, v7
    v_lshlrev_b32 v6, 16, v5
    v_and_b32 v5, 0xffff0000, v5
    v_add_f32 v4, v4, v6
    v_add_f32 v4, v4, v5
    v_lshlrev_b32 v5, 16, v39
    v_lshlrev_b32 v6, 16, v79
    v_mul_f32 v5, v5, v6
    v_and_b32 v7, 0xffff0000, v39
    v_and_b32 v6, 0xffff0000, v79
    v_mul_f32 v7, v7, v6
    v_cvt_pk_bf16_f32 v5, v5, v7
    v_lshlrev_b32 v6, 16, v5
    v_and_b32 v5, 0xffff0000, v5
    v_add_f32 v4, v4, v6
    v_add_f32 v4, v4, v5
    v_lshlrev_b32 v5, 16, v40
    v_lshlrev_b32 v6, 16, v80
    v_mul_f32 v5, v5, v6
    v_and_b32 v7, 0xffff0000, v40
    v_and_b32 v6, 0xffff0000, v80
    v_mul_f32 v7, v7, v6
    v_cvt_pk_bf16_f32 v5, v5, v7
    v_lshlrev_b32 v6, 16, v5
    v_and_b32 v5, 0xffff0000, v5
    v_add_f32 v4, v4, v6
    v_add_f32 v4, v4, v5
    v_lshlrev_b32 v5, 16, v41
    v_lshlrev_b32 v6, 16, v81
    v_mul_f32 v5, v5, v6
    v_and_b32 v7, 0xffff0000, v41
    v_and_b32 v6, 0xffff0000, v81
    v_mul_f32 v7, v7, v6
    v_cvt_pk_bf16_f32 v5, v5, v7
    v_lshlrev_b32 v6, 16, v5
    v_and_b32 v5, 0xffff0000, v5
    v_add_f32 v4, v4, v6
    v_add_f32 v4, v4, v5
    v_lshlrev_b32 v5, 16, v42
    v_lshlrev_b32 v6, 16, v82
    v_mul_f32 v5, v5, v6
    v_and_b32 v7, 0xffff0000, v42
    v_and_b32 v6, 0xffff0000, v82
    v_mul_f32 v7, v7, v6
    v_cvt_pk_bf16_f32 v5, v5, v7
    v_lshlrev_b32 v6, 16, v5
    v_and_b32 v5, 0xffff0000, v5
    v_add_f32 v4, v4, v6
    v_add_f32 v4, v4, v5
    v_lshlrev_b32 v5, 16, v43
    v_lshlrev_b32 v6, 16, v83
    v_mul_f32 v5, v5, v6
    v_and_b32 v7, 0xffff0000, v43
    v_and_b32 v6, 0xffff0000, v83
    v_mul_f32 v7, v7, v6
    v_cvt_pk_bf16_f32 v5, v5, v7
    v_lshlrev_b32 v6, 16, v5
    v_and_b32 v5, 0xffff0000, v5
    v_add_f32 v4, v4, v6
    v_add_f32 v4, v4, v5
    v_lshlrev_b32 v5, 16, v44
    v_lshlrev_b32 v6, 16, v84
    v_mul_f32 v5, v5, v6
    v_and_b32 v7, 0xffff0000, v44
    v_and_b32 v6, 0xffff0000, v84
    v_mul_f32 v7, v7, v6
    v_cvt_pk_bf16_f32 v5, v5, v7
    v_lshlrev_b32 v6, 16, v5
    v_and_b32 v5, 0xffff0000, v5
    v_add_f32 v4, v4, v6
    v_add_f32 v4, v4, v5
    v_lshlrev_b32 v5, 16, v45
    v_lshlrev_b32 v6, 16, v85
    v_mul_f32 v5, v5, v6
    v_and_b32 v7, 0xffff0000, v45
    v_and_b32 v6, 0xffff0000, v85
    v_mul_f32 v7, v7, v6
    v_cvt_pk_bf16_f32 v5, v5, v7
    v_lshlrev_b32 v6, 16, v5
    v_and_b32 v5, 0xffff0000, v5
    v_add_f32 v4, v4, v6
    v_add_f32 v4, v4, v5
    v_lshlrev_b32 v5, 16, v46
    v_lshlrev_b32 v6, 16, v86
    v_mul_f32 v5, v5, v6
    v_and_b32 v7, 0xffff0000, v46
    v_and_b32 v6, 0xffff0000, v86
    v_mul_f32 v7, v7, v6
    v_cvt_pk_bf16_f32 v5, v5, v7
    v_lshlrev_b32 v6, 16, v5
    v_and_b32 v5, 0xffff0000, v5
    v_add_f32 v4, v4, v6
    v_add_f32 v4, v4, v5
    v_lshlrev_b32 v5, 16, v47
    v_lshlrev_b32 v6, 16, v87
    v_mul_f32 v5, v5, v6
    v_and_b32 v7, 0xffff0000, v47
    v_and_b32 v6, 0xffff0000, v87
    v_mul_f32 v7, v7, v6
    v_cvt_pk_bf16_f32 v5, v5, v7
    v_lshlrev_b32 v6, 16, v5
    v_and_b32 v5, 0xffff0000, v5
    v_add_f32 v4, v4, v6
    v_add_f32 v4, v4, v5
    v_lshlrev_b32 v5, 16, v48
    v_lshlrev_b32 v6, 16, v88
    v_mul_f32 v5, v5, v6
    v_and_b32 v7, 0xffff0000, v48
    v_and_b32 v6, 0xffff0000, v88
    v_mul_f32 v7, v7, v6
    v_cvt_pk_bf16_f32 v5, v5, v7
    v_lshlrev_b32 v6, 16, v5
    v_and_b32 v5, 0xffff0000, v5
    v_add_f32 v4, v4, v6
    v_add_f32 v4, v4, v5
    v_lshlrev_b32 v5, 16, v49
    v_lshlrev_b32 v6, 16, v89
    v_mul_f32 v5, v5, v6
    v_and_b32 v7, 0xffff0000, v49
    v_and_b32 v6, 0xffff0000, v89
    v_mul_f32 v7, v7, v6
    v_cvt_pk_bf16_f32 v5, v5, v7
    v_lshlrev_b32 v6, 16, v5
    v_and_b32 v5, 0xffff0000, v5
    v_add_f32 v4, v4, v6
    v_add_f32 v4, v4, v5
    v_lshlrev_b32 v5, 16, v50
    v_lshlrev_b32 v6, 16, v90
    v_mul_f32 v5, v5, v6
    v_and_b32 v7, 0xffff0000, v50
    v_and_b32 v6, 0xffff0000, v90
    v_mul_f32 v7, v7, v6
    v_cvt_pk_bf16_f32 v5, v5, v7
    v_lshlrev_b32 v6, 16, v5
    v_and_b32 v5, 0xffff0000, v5
    v_add_f32 v4, v4, v6
    v_add_f32 v4, v4, v5
    v_lshlrev_b32 v5, 16, v51
    v_lshlrev_b32 v6, 16, v91
    v_mul_f32 v5, v5, v6
    v_and_b32 v7, 0xffff0000, v51
    v_and_b32 v6, 0xffff0000, v91
    v_mul_f32 v7, v7, v6
    v_cvt_pk_bf16_f32 v5, v5, v7
    v_lshlrev_b32 v6, 16, v5
    v_and_b32 v5, 0xffff0000, v5
    v_add_f32 v4, v4, v6
    v_add_f32 v4, v4, v5
    ds_swizzle_b32 v5, v4 offset:0x41f
    s_waitcnt lgkmcnt(0)
    v_add_f32 v4, v4, v5
    ds_swizzle_b32 v5, v4 offset:0x81f
    s_waitcnt lgkmcnt(0)
    v_add_f32 v4, v4, v5
    ds_swizzle_b32 v5, v4 offset:0x101f
    s_waitcnt lgkmcnt(0)
    v_add_f32 v4, v4, v5
    v_cvt_pk_bf16_f32 v5, v4, v4
    v_lshlrev_b32 v5, 16, v5
    v_mul_f32 v5, 0xbfb8aa3b, v5
    v_exp_f32 v5, v5
    s_nop 0
    v_add_f32 v5, 1.0, v5
    v_rcp_f32 v5, v5
    s_nop 0
    v_cvt_pk_bf16_f32 v5, v5, v5
    v_lshlrev_b32 v5, 16, v5
    v_lshlrev_b32 v6, 2, v1
    v_cmp_eq_u32 vcc, 0, v3
    s_nop 1
    s_and_saveexec_b64 s[60:61], vcc
    s_cbranch_execz Ldone_2
    s_mov_b32 s28, 88080384
    buffer_store_dword v5, v6, s[16:19], s28 offen
Ldone_2:
    s_endpgm
.p2align 8
k2_attn_kernel:
    s_cmp_ge_u32 s2, 512
    s_cbranch_scc1 Ldone_19
    s_load_dwordx2 s[6:7], s[0:1], 96
    s_and_b32 s20, s2, 31
    s_lshr_b32 s21, s2, 5
    s_sub_u32 s22, 15, s21
    s_sub_u32 s23, s21, 8
    s_cmp_lt_u32 s2, 256
    s_cselect_b32 s21, s22, s23
    v_lshrrev_b32 v1, 6, v0
    v_and_b32 v0, 63, v0
    s_nop 0
    v_readfirstlane_b32 s25, v1
    s_waitcnt lgkmcnt(0)
    s_mov_b32 s8, s6
    s_and_b32 s9, s7, 0xffff
    s_mov_b32 s10, 268435456
    s_mov_b32 s11, 0x20000
    s_add_u32 s22, s21, 1
    s_lshl_b32 s22, s22, 1
    v_lshrrev_b32 v1, 4, v0
    s_lshl_b32 s28, s25, 2
    v_add_u32 v2, s28, v1
    v_and_b32 v3, 15, v0
    v_xor_b32 v2, v2, v3
    v_lshlrev_b32 v2, 4, v2
    v_lshlrev_b32 v8, 13, v1
    v_add_u32 v8, v8, v2
    s_and_b32 s28, s25, 1
    s_lshl_b32 s28, s28, 2
    v_add_u32 v2, s28, v1
    v_and_b32 v2, 7, v2
    v_and_b32 v3, 7, v0
    v_xor_b32 v2, v2, v3
    v_lshlrev_b32 v2, 4, v2
    v_lshrrev_b32 v3, 3, v0
    v_lshlrev_b32 v9, 12, v3
    v_add_u32 v9, v9, v2
    v_lshrrev_b32 v1, 5, v0
    v_and_b32 v2, 15, v0
    v_xor_b32 v1, v1, v2
    v_lshlrev_b32 v1, 4, v1
    v_and_b32 v2, 31, v0
    v_lshlrev_b32 v2, 8, v2
    v_add_u32 v1, v1, v2
    v_xor_b32 v10, 0, v1
    v_xor_b32 v11, 32, v1
    v_xor_b32 v12, 64, v1
    v_xor_b32 v13, 96, v1
    v_xor_b32 v14, 128, v1
    v_xor_b32 v15, 160, v1
    v_xor_b32 v16, 192, v1
    v_xor_b32 v17, 224, v1
    v_and_b32 v1, 31, v0
    v_lshlrev_b32 v1, 7, v1
    v_add_u32 v1, 16384, v1
    v_lshrrev_b32 v2, 5, v0
    v_bfe_u32 v3, v0, 1, 3
    v_xor_b32 v2, v2, v3
    v_xor_b32 v3, 0, v2
    v_lshlrev_b32 v3, 4, v3
    v_add_u32 v18, v1, v3
    v_xor_b32 v3, 2, v2
    v_lshlrev_b32 v3, 4, v3
    v_add_u32 v19, v1, v3
    v_xor_b32 v3, 4, v2
    v_lshlrev_b32 v3, 4, v3
    v_add_u32 v20, v1, v3
    v_xor_b32 v3, 6, v2
    v_lshlrev_b32 v3, 4, v3
    v_add_u32 v21, v1, v3
    s_lshl_b32 s28, s20, 8
    s_add_u32 s28, s28, 16777216
    s_lshl_b32 s29, s25, 15
    s_add_u32 s28, s28, s29
    s_add_u32 s32, s28, 0
    s_add_u32 s33, s28, 131072
    s_add_u32 s34, s28, 262144
    s_add_u32 s35, s28, 393216
    s_lshl_b32 s28, s20, 19
    s_add_u32 s28, s28, 33554432
    s_lshl_b32 s29, s25, 15
    s_add_u32 s28, s28, s29
    s_add_u32 s36, s28, 0
    s_add_u32 s37, s28, 131072
    s_add_u32 s38, s28, 262144
    s_add_u32 s39, s28, 393216
    s_lshl_b32 s31, s25, 10
    s_add_u32 m0, s31, 0
    s_nop 0
    buffer_load_dwordx4 v8, s[8:11], s32 offen lds
    s_add_u32 s32, s32, 524288
    s_add_u32 m0, s31, 4096
    s_nop 0
    buffer_load_dwordx4 v8, s[8:11], s33 offen lds
    s_add_u32 s33, s33, 524288
    s_add_u32 m0, s31, 8192
    s_nop 0
    buffer_load_dwordx4 v8, s[8:11], s34 offen lds
    s_add_u32 s34, s34, 524288
    s_add_u32 m0, s31, 12288
    s_nop 0
    buffer_load_dwordx4 v8, s[8:11], s35 offen lds
    s_add_u32 s35, s35, 524288
    s_add_u32 m0, s31, 16384
    s_nop 0
    buffer_load_dwordx4 v9, s[8:11], s36 offen lds
    s_add_u32 s36, s36, 128
    s_add_u32 m0, s31, 20480
    s_nop 0
    buffer_load_dwordx4 v9, s[8:11], s37 offen lds
    s_add_u32 s37, s37, 128
    s_add_u32 m0, s31, 24576
    s_nop 0
    buffer_load_dwordx4 v9, s[8:11], s38 offen lds
    s_add_u32 s38, s38, 128
    s_add_u32 m0, s31, 28672
    s_nop 0
    buffer_load_dwordx4 v9, s[8:11], s39 offen lds
    s_add_u32 s39, s39, 128
    s_xor_b32 s31, s31, 32768
    v_and_b32 v1, 31, v0
    s_lshl_b32 s28, s25, 5
    v_add_u32 v26, s28, v1
    v_lshlrev_b32 v1, 13, v26
    v_lshrrev_b32 v2, 5, v0
    v_lshlrev_b32 v2, 4, v2
    v_add_u32 v27, v1, v2
    s_lshl_b32 s28, s21, 20
    s_lshl_b32 s29, s20, 8
    s_add_u32 s40, s28, s29
    s_add_u32 s41, s40, 0
    buffer_load_dwordx4 v[32:35], v27, s[8:11], s41 offen offset:0
    buffer_load_dwordx4 v[36:39], v27, s[8:11], s41 offen offset:32
    buffer_load_dwordx4 v[40:43], v27, s[8:11], s41 offen offset:64
    buffer_load_dwordx4 v[44:47], v27, s[8:11], s41 offen offset:96
    buffer_load_dwordx4 v[48:51], v27, s[8:11], s41 offen offset:128
    buffer_load_dwordx4 v[52:55], v27, s[8:11], s41 offen offset:160
    buffer_load_dwordx4 v[56:59], v27, s[8:11], s41 offen offset:192
    buffer_load_dwordx4 v[60:63], v27, s[8:11], s41 offen offset:224
    s_lshl_b32 s28, s21, 7
    v_add_u32 v26, s28, v26
    v_lshrrev_b32 v2, 5, v0
    v_lshlrev_b32 v2, 2, v2
    v_sub_u32 v26, v26, v2
    v_mov_b32 v22, 0xff800000
    v_mov_b32 v23, 0
    v_mov_b32 v64, 0
    v_mov_b32 v65, 0
    v_mov_b32 v66, 0
    v_mov_b32 v67, 0
    v_mov_b32 v68, 0
    v_mov_b32 v69, 0
    v_mov_b32 v70, 0
    v_mov_b32 v71, 0
    v_mov_b32 v72, 0
    v_mov_b32 v73, 0
    v_mov_b32 v74, 0
    v_mov_b32 v75, 0
    v_mov_b32 v76, 0
    v_mov_b32 v77, 0
    v_mov_b32 v78, 0
    v_mov_b32 v79, 0
    v_mov_b32 v80, 0
    v_mov_b32 v81, 0
    v_mov_b32 v82, 0
    v_mov_b32 v83, 0
    v_mov_b32 v84, 0
    v_mov_b32 v85, 0
    v_mov_b32 v86, 0
    v_mov_b32 v87, 0
    v_mov_b32 v88, 0
    v_mov_b32 v89, 0
    v_mov_b32 v90, 0
    v_mov_b32 v91, 0
    v_mov_b32 v92, 0
    v_mov_b32 v93, 0
    v_mov_b32 v94, 0
    v_mov_b32 v95, 0
    v_mov_b32 v96, 0
    v_mov_b32 v97, 0
    v_mov_b32 v98, 0
    v_mov_b32 v99, 0
    v_mov_b32 v100, 0
    v_mov_b32 v101, 0
    v_mov_b32 v102, 0
    v_mov_b32 v103, 0
    v_mov_b32 v104, 0
    v_mov_b32 v105, 0
    v_mov_b32 v106, 0
    v_mov_b32 v107, 0
    v_mov_b32 v108, 0
    v_mov_b32 v109, 0
    v_mov_b32 v110, 0
    v_mov_b32 v111, 0
    v_mov_b32 v112, 0
    v_mov_b32 v113, 0
    v_mov_b32 v114, 0
    v_mov_b32 v115, 0
    v_mov_b32 v116, 0
    v_mov_b32 v117, 0
    v_mov_b32 v118, 0
    v_mov_b32 v119, 0
    v_mov_b32 v120, 0
    v_mov_b32 v121, 0
    v_mov_b32 v122, 0
    v_mov_b32 v123, 0
    v_mov_b32 v124, 0
    v_mov_b32 v125, 0
    v_mov_b32 v126, 0
    v_mov_b32 v127, 0
    s_mov_b32 s48, 0
    s_lshl_b32 s42, s21, 1
    s_mov_b32 s43, 0x3e0293ee
Lt_20:
    s_add_u32 s49, s48, 1
    s_cmp_lt_u32 s49, s22
    s_cbranch_scc0 Lskip_21
    s_add_u32 m0, s31, 0
    s_nop 0
    buffer_load_dwordx4 v8, s[8:11], s32 offen lds
    s_add_u32 s32, s32, 524288
    s_add_u32 m0, s31, 4096
    s_nop 0
    buffer_load_dwordx4 v8, s[8:11], s33 offen lds
    s_add_u32 s33, s33, 524288
    s_add_u32 m0, s31, 8192
    s_nop 0
    buffer_load_dwordx4 v8, s[8:11], s34 offen lds
    s_add_u32 s34, s34, 524288
    s_add_u32 m0, s31, 12288
    s_nop 0
    buffer_load_dwordx4 v8, s[8:11], s35 offen lds
    s_add_u32 s35, s35, 524288
    s_add_u32 m0, s31, 16384
    s_nop 0
    buffer_load_dwordx4 v9, s[8:11], s36 offen lds
    s_add_u32 s36, s36, 128
    s_add_u32 m0, s31, 20480
    s_nop 0
    buffer_load_dwordx4 v9, s[8:11], s37 offen lds
    s_add_u32 s37, s37, 128
    s_add_u32 m0, s31, 24576
    s_nop 0
    buffer_load_dwordx4 v9, s[8:11], s38 offen lds
    s_add_u32 s38, s38, 128
    s_add_u32 m0, s31, 28672
    s_nop 0
    buffer_load_dwordx4 v9, s[8:11], s39 offen lds
    s_add_u32 s39, s39, 128
    s_xor_b32 s31, s31, 32768
    s_waitcnt vmcnt(8)
    s_branch Ljoin_22
Lskip_21:
    s_waitcnt vmcnt(0)
Ljoin_22:
    s_barrier
    v_mov_b32 v128, 0
    v_mov_b32 v129, 0
    v_mov_b32 v130, 0
    v_mov_b32 v131, 0
    v_mov_b32 v132, 0
    v_mov_b32 v133, 0
    v_mov_b32 v134, 0
    v_mov_b32 v135, 0
    v_mov_b32 v136, 0
    v_mov_b32 v137, 0
    v_mov_b32 v138, 0
    v_mov_b32 v139, 0
    v_mov_b32 v140, 0
    v_mov_b32 v141, 0
    v_mov_b32 v142, 0
    v_mov_b32 v143, 0
    v_mov_b32 v144, 0
    v_mov_b32 v145, 0
    v_mov_b32 v146, 0
    v_mov_b32 v147, 0
    v_mov_b32 v148, 0
    v_mov_b32 v149, 0
    v_mov_b32 v150, 0
    v_mov_b32 v151, 0
    v_mov_b32 v152, 0
    v_mov_b32 v153, 0
    v_mov_b32 v154, 0
    v_mov_b32 v155, 0
    v_mov_b32 v156, 0
    v_mov_b32 v157, 0
    v_mov_b32 v158, 0
    v_mov_b32 v159, 0
    ds_read_b128 v[176:179], v10 offset:0
    ds_read_b128 v[180:183], v11 offset:0
    ds_read_b128 v[184:187], v12 offset:0
    ds_read_b128 v[188:191], v13 offset:0
    s_waitcnt lgkmcnt(3)
    v_mfma_f32_32x32x16_bf16 v[128:143], v[176:179], v[32:35], v[128:143]
    ds_read_b128 v[176:179], v14 offset:0
    s_waitcnt lgkmcnt(3)
    v_mfma_f32_32x32x16_bf16 v[128:143], v[180:183], v[36:39], v[128:143]
    ds_read_b128 v[180:183], v15 offset:0
    s_waitcnt lgkmcnt(3)
    v_mfma_f32_32x32x16_bf16 v[128:143], v[184:187], v[40:43], v[128:143]
    ds_read_b128 v[184:187], v16 offset:0
    s_waitcnt lgkmcnt(3)
    v_mfma_f32_32x32x16_bf16 v[128:143], v[188:191], v[44:47], v[128:143]
    ds_read_b128 v[188:191], v17 offset:0
    s_waitcnt lgkmcnt(3)
    v_mfma_f32_32x32x16_bf16 v[128:143], v[176:179], v[48:51], v[128:143]
    ds_read_b128 v[176:179], v10 offset:8192
    s_waitcnt lgkmcnt(3)
    v_mfma_f32_32x32x16_bf16 v[128:143], v[180:183], v[52:55], v[128:143]
    ds_read_b128 v[180:183], v11 offset:8192
    s_waitcnt lgkmcnt(3)
    v_mfma_f32_32x32x16_bf16 v[128:143], v[184:187], v[56:59], v[128:143]
    ds_read_b128 v[184:187], v12 offset:8192
    s_waitcnt lgkmcnt(3)
    v_mfma_f32_32x32x16_bf16 v[128:143], v[188:191], v[60:63], v[128:143]
    ds_read_b128 v[188:191], v13 offset:8192
    s_waitcnt lgkmcnt(3)
    v_mfma_f32_32x32x16_bf16 v[144:159], v[176:179], v[32:35], v[144:159]
    ds_read_b128 v[176:179], v14 offset:8192
    s_waitcnt lgkmcnt(3)
    v_mfma_f32_32x32x16_bf16 v[144:159], v[180:183], v[36:39], v[144:159]
    ds_read_b128 v[180:183], v15 offset:8192
    s_waitcnt lgkmcnt(3)
    v_mfma_f32_32x32x16_bf16 v[144:159], v[184:187], v[40:43], v[144:159]
    ds_read_b128 v[184:187], v16 offset:8192
    s_waitcnt lgkmcnt(3)
    v_mfma_f32_32x32x16_bf16 v[144:159], v[188:191], v[44:47], v[144:159]
    ds_read_b128 v[188:191], v17 offset:8192
    s_waitcnt lgkmcnt(3)
    v_mfma_f32_32x32x16_bf16 v[144:159], v[176:179], v[48:51], v[144:159]
    s_waitcnt lgkmcnt(2)
    v_mfma_f32_32x32x16_bf16 v[144:159], v[180:183], v[52:55], v[144:159]
    s_waitcnt lgkmcnt(1)
    v_mfma_f32_32x32x16_bf16 v[144:159], v[184:187], v[56:59], v[144:159]
    s_waitcnt lgkmcnt(0)
    v_mfma_f32_32x32x16_bf16 v[144:159], v[188:191], v[60:63], v[144:159]
    ds_read_b128 v[176:179], v18 offset:0
    ds_read_b128 v[180:183], v19 offset:0
    ds_read_b128 v[184:187], v20 offset:0
    ds_read_b128 v[188:191], v21 offset:0
    s_nop 7
    s_nop 3
    s_cmp_lt_u32 s48, s42
    s_cbranch_scc1 Lnomask_23
    v_mov_b32 v2, 0xff800000
    v_cmp_lt_i32 vcc, v26, 0
    s_nop 1
    v_cndmask_b32 v128, v128, v2, vcc
    v_cmp_lt_i32 vcc, v26, 1
    s_nop 1
    v_cndmask_b32 v129, v129, v2, vcc
    v_cmp_lt_i32 vcc, v26, 2
    s_nop 1
    v_cndmask_b32 v130, v130, v2, vcc
    v_cmp_lt_i32 vcc, v26, 3
    s_nop 1
    v_cndmask_b32 v131, v131, v2, vcc
    v_cmp_lt_i32 vcc, v26, 8
    s_nop 1
    v_cndmask_b32 v132, v132, v2, vcc
    v_cmp_lt_i32 vcc, v26, 9
    s_nop 1
    v_cndmask_b32 v133, v133, v2, vcc
    v_cmp_lt_i32 vcc, v26, 10
    s_nop 1
    v_cndmask_b32 v134, v134, v2, vcc
    v_cmp_lt_i32 vcc, v26, 11
    s_nop 1
    v_cndmask_b32 v135, v135, v2, vcc
    v_cmp_lt_i32 vcc, v26, 16
    s_nop 1
    v_cndmask_b32 v136, v136, v2, vcc
    v_cmp_lt_i32 vcc, v26, 17
    s_nop 1
    v_cndmask_b32 v137, v137, v2, vcc
    v_cmp_lt_i32 vcc, v26, 18
    s_nop 1
    v_cndmask_b32 v138, v138, v2, vcc
    v_cmp_lt_i32 vcc, v26, 19
    s_nop 1
    v_cndmask_b32 v139, v139, v2, vcc
    v_cmp_lt_i32 vcc, v26, 24
    s_nop 1
    v_cndmask_b32 v140, v140, v2, vcc
    v_cmp_lt_i32 vcc, v26, 25
    s_nop 1
    v_cndmask_b32 v141, v141, v2, vcc
    v_cmp_lt_i32 vcc, v26, 26
    s_nop 1
    v_cndmask_b32 v142, v142, v2, vcc
    v_cmp_lt_i32 vcc, v26, 27
    s_nop 1
    v_cndmask_b32 v143, v143, v2, vcc
    v_cmp_lt_i32 vcc, v26, 32
    s_nop 1
    v_cndmask_b32 v144, v144, v2, vcc
    v_cmp_lt_i32 vcc, v26, 33
    s_nop 1
    v_cndmask_b32 v145, v145, v2, vcc
    v_cmp_lt_i32 vcc, v26, 34
    s_nop 1
    v_cndmask_b32 v146, v146, v2, vcc
    v_cmp_lt_i32 vcc, v26, 35
    s_nop 1
    v_cndmask_b32 v147, v147, v2, vcc
    v_cmp_lt_i32 vcc, v26, 40
    s_nop 1
    v_cndmask_b32 v148, v148, v2, vcc
    v_cmp_lt_i32 vcc, v26, 41
    s_nop 1
    v_cndmask_b32 v149, v149, v2, vcc
    v_cmp_lt_i32 vcc, v26, 42
    s_nop 1
    v_cndmask_b32 v150, v150, v2, vcc
    v_cmp_lt_i32 vcc, v26, 43
    s_nop 1
    v_cndmask_b32 v151, v151, v2, vcc
    v_cmp_lt_i32 vcc, v26, 48
    s_nop 1
    v_cndmask_b32 v152, v152, v2, vcc
    v_cmp_lt_i32 vcc, v26, 49
    s_nop 1
    v_cndmask_b32 v153, v153, v2, vcc
    v_cmp_lt_i32 vcc, v26, 50
    s_nop 1
    v_cndmask_b32 v154, v154, v2, vcc
    v_cmp_lt_i32 vcc, v26, 51
    s_nop 1
    v_cndmask_b32 v155, v155, v2, vcc
    v_cmp_lt_i32 vcc, v26, 56
    s_nop 1
    v_cndmask_b32 v156, v156, v2, vcc
    v_cmp_lt_i32 vcc, v26, 57
    s_nop 1
    v_cndmask_b32 v157, v157, v2, vcc
    v_cmp_lt_i32 vcc, v26, 58
    s_nop 1
    v_cndmask_b32 v158, v158, v2, vcc
    v_cmp_lt_i32 vcc, v26, 59
    s_nop 1
    v_cndmask_b32 v159, v159, v2, vcc
Lnomask_23:
    v_max3_f32 v1, v128, v129, v130
    v_max3_f32 v1, v1, v131, v132
    v_max3_f32 v1, v1, v133, v134
    v_max3_f32 v1, v1, v135, v136
    v_max3_f32 v1, v1, v137, v138
    v_max3_f32 v1, v1, v139, v140
    v_max3_f32 v1, v1, v141, v142
    v_max3_f32 v1, v1, v143, v144
    v_max3_f32 v1, v1, v145, v146
    v_max3_f32 v1, v1, v147, v148
    v_max3_f32 v1, v1, v149, v150
    v_max3_f32 v1, v1, v151, v152
    v_max3_f32 v1, v1, v153, v154
    v_max3_f32 v1, v1, v155, v156
    v_max3_f32 v1, v1, v157, v158
    v_max_f32 v1, v1, v159
    v_mov_b32 v2, v1
    s_nop 1
    v_permlane32_swap_b32 v1, v2
    s_nop 1
    v_max_f32 v1, v1, v2
    v_cmp_gt_f32 vcc, v1, v22
    v_max_f32 v24, v1, v22
    v_sub_f32 v2, v22, v24
    v_mul_f32 v2, s43, v2
    v_exp_f32 v3, v2
    v_mov_b32 v22, v24
    v_mul_f32 v25, s43, v24
    s_cbranch_vccz Lnoresc_24
    v_mul_f32 v23, v23, v3
    v_mul_f32 v64, v64, v3
    v_mul_f32 v65, v65, v3
    v_mul_f32 v66, v66, v3
    v_mul_f32 v67, v67, v3
    v_mul_f32 v68, v68, v3
    v_mul_f32 v69, v69, v3
    v_mul_f32 v70, v70, v3
    v_mul_f32 v71, v71, v3
    v_mul_f32 v72, v72, v3
    v_mul_f32 v73, v73, v3
    v_mul_f32 v74, v74, v3
    v_mul_f32 v75, v75, v3
    v_mul_f32 v76, v76, v3
    v_mul_f32 v77, v77, v3
    v_mul_f32 v78, v78, v3
    v_mul_f32 v79, v79, v3
    v_mul_f32 v80, v80, v3
    v_mul_f32 v81, v81, v3
    v_mul_f32 v82, v82, v3
    v_mul_f32 v83, v83, v3
    v_mul_f32 v84, v84, v3
    v_mul_f32 v85, v85, v3
    v_mul_f32 v86, v86, v3
    v_mul_f32 v87, v87, v3
    v_mul_f32 v88, v88, v3
    v_mul_f32 v89, v89, v3
    v_mul_f32 v90, v90, v3
    v_mul_f32 v91, v91, v3
    v_mul_f32 v92, v92, v3
    v_mul_f32 v93, v93, v3
    v_mul_f32 v94, v94, v3
    v_mul_f32 v95, v95, v3
    v_mul_f32 v96, v96, v3
    v_mul_f32 v97, v97, v3
    v_mul_f32 v98, v98, v3
    v_mul_f32 v99, v99, v3
    v_mul_f32 v100, v100, v3
    v_mul_f32 v101, v101, v3
    v_mul_f32 v102, v102, v3
    v_mul_f32 v103, v103, v3
    v_mul_f32 v104, v104, v3
    v_mul_f32 v105, v105, v3
    v_mul_f32 v106, v106, v3
    v_mul_f32 v107, v107, v3
    v_mul_f32 v108, v108, v3
    v_mul_f32 v109, v109, v3
    v_mul_f32 v110, v110, v3
    v_mul_f32 v111, v111, v3
    v_mul_f32 v112, v112, v3
    v_mul_f32 v113, v113, v3
    v_mul_f32 v114, v114, v3
    v_mul_f32 v115, v115, v3
    v_mul_f32 v116, v116, v3
    v_mul_f32 v117, v117, v3
    v_mul_f32 v118, v118, v3
    v_mul_f32 v119, v119, v3
    v_mul_f32 v120, v120, v3
    v_mul_f32 v121, v121, v3
    v_mul_f32 v122, v122, v3
    v_mul_f32 v123, v123, v3
    v_mul_f32 v124, v124, v3
    v_mul_f32 v125, v125, v3
    v_mul_f32 v126, v126, v3
    v_mul_f32 v127, v127, v3
Lnoresc_24:
    v_fma_f32 v128, v128, s43, -v25
    v_exp_f32 v128, v128
    v_fma_f32 v129, v129, s43, -v25
    v_exp_f32 v129, v129
    v_fma_f32 v130, v130, s43, -v25
    v_exp_f32 v130, v130
    v_fma_f32 v131, v131, s43, -v25
    v_exp_f32 v131, v131
    v_fma_f32 v132, v132, s43, -v25
    v_exp_f32 v132, v132
    v_fma_f32 v133, v133, s43, -v25
    v_exp_f32 v133, v133
    v_fma_f32 v134, v134, s43, -v25
    v_exp_f32 v134, v134
    v_fma_f32 v135, v135, s43, -v25
    v_exp_f32 v135, v135
    v_fma_f32 v136, v136, s43, -v25
    v_exp_f32 v136, v136
    v_fma_f32 v137, v137, s43, -v25
    v_exp_f32 v137, v137
    v_fma_f32 v138, v138, s43, -v25
    v_exp_f32 v138, v138
    v_fma_f32 v139, v139, s43, -v25
    v_exp_f32 v139, v139
    v_fma_f32 v140, v140, s43, -v25
    v_exp_f32 v140, v140
    v_fma_f32 v141, v141, s43, -v25
    v_exp_f32 v141, v141
    v_fma_f32 v142, v142, s43, -v25
    v_exp_f32 v142, v142
    v_fma_f32 v143, v143, s43, -v25
    v_exp_f32 v143, v143
    v_fma_f32 v144, v144, s43, -v25
    v_exp_f32 v144, v144
    v_fma_f32 v145, v145, s43, -v25
    v_exp_f32 v145, v145
    v_fma_f32 v146, v146, s43, -v25
    v_exp_f32 v146, v146
    v_fma_f32 v147, v147, s43, -v25
    v_exp_f32 v147, v147
    v_fma_f32 v148, v148, s43, -v25
    v_exp_f32 v148, v148
    v_fma_f32 v149, v149, s43, -v25
    v_exp_f32 v149, v149
    v_fma_f32 v150, v150, s43, -v25
    v_exp_f32 v150, v150
    v_fma_f32 v151, v151, s43, -v25
    v_exp_f32 v151, v151
    v_fma_f32 v152, v152, s43, -v25
    v_exp_f32 v152, v152
    v_fma_f32 v153, v153, s43, -v25
    v_exp_f32 v153, v153
    v_fma_f32 v154, v154, s43, -v25
    v_exp_f32 v154, v154
    v_fma_f32 v155, v155, s43, -v25
    v_exp_f32 v155, v155
    v_fma_f32 v156, v156, s43, -v25
    v_exp_f32 v156, v156
    v_fma_f32 v157, v157, s43, -v25
    v_exp_f32 v157, v157
    v_fma_f32 v158, v158, s43, -v25
    v_exp_f32 v158, v158
    v_fma_f32 v159, v159, s43, -v25
    v_exp_f32 v159, v159
    s_nop 0
    v_add_f32 v1, v128, v129
    v_add_f32 v1, v1, v130
    v_add_f32 v1, v1, v131
    v_add_f32 v1, v1, v132
    v_add_f32 v1, v1, v133
    v_add_f32 v1, v1, v134
    v_add_f32 v1, v1, v135
    v_add_f32 v1, v1, v136
    v_add_f32 v1, v1, v137
    v_add_f32 v1, v1, v138
    v_add_f32 v1, v1, v139
    v_add_f32 v1, v1, v140
    v_add_f32 v1, v1, v141
    v_add_f32 v1, v1, v142
    v_add_f32 v1, v1, v143
    v_add_f32 v1, v1, v144
    v_add_f32 v1, v1, v145
    v_add_f32 v1, v1, v146
    v_add_f32 v1, v1, v147
    v_add_f32 v1, v1, v148
    v_add_f32 v1, v1, v149
    v_add_f32 v1, v1, v150
    v_add_f32 v1, v1, v151
    v_add_f32 v1, v1, v152
    v_add_f32 v1, v1, v153
    v_add_f32 v1, v1, v154
    v_add_f32 v1, v1, v155
    v_add_f32 v1, v1, v156
    v_add_f32 v1, v1, v157
    v_add_f32 v1, v1, v158
    v_add_f32 v1, v1, v159
    v_add_f32 v23, v23, v1
    v_cvt_pk_bf16_f32 v160, v128, v129
    v_cvt_pk_bf16_f32 v161, v130, v131
    v_cvt_pk_bf16_f32 v162, v132, v133
    v_cvt_pk_bf16_f32 v163, v134, v135
    v_cvt_pk_bf16_f32 v164, v136, v137
    v_cvt_pk_bf16_f32 v165, v138, v139
    v_cvt_pk_bf16_f32 v166, v140, v141
    v_cvt_pk_bf16_f32 v167, v142, v143
    v_cvt_pk_bf16_f32 v168, v144, v145
    v_cvt_pk_bf16_f32 v169, v146, v147
    v_cvt_pk_bf16_f32 v170, v148, v149
    v_cvt_pk_bf16_f32 v171, v150, v151
    v_cvt_pk_bf16_f32 v172, v152, v153
    v_cvt_pk_bf16_f32 v173, v154, v155
    v_cvt_pk_bf16_f32 v174, v156, v157
    v_cvt_pk_bf16_f32 v175, v158, v159
    s_nop 1
    s_waitcnt lgkmcnt(3)
    v_mfma_f32_32x32x16_bf16 v[64:79], v[176:179], v[160:163], v[64:79]
    ds_read_b128 v[176:179], v18 offset:4096
    s_waitcnt lgkmcnt(3)
    v_mfma_f32_32x32x16_bf16 v[64:79], v[180:183], v[164:167], v[64:79]
    ds_read_b128 v[180:183], v19 offset:4096
    s_waitcnt lgkmcnt(3)
    v_mfma_f32_32x32x16_bf16 v[64:79], v[184:187], v[168:171], v[64:79]
    ds_read_b128 v[184:187], v20 offset:4096
    s_waitcnt lgkmcnt(3)
    v_mfma_f32_32x32x16_bf16 v[64:79], v[188:191], v[172:175], v[64:79]
    ds_read_b128 v[188:191], v21 offset:4096
    s_waitcnt lgkmcnt(3)
    v_mfma_f32_32x32x16_bf16 v[80:95], v[176:179], v[160:163], v[80:95]
    ds_read_b128 v[176:179], v18 offset:8192
    s_waitcnt lgkmcnt(3)
    v_mfma_f32_32x32x16_bf16 v[80:95], v[180:183], v[164:167], v[80:95]
    ds_read_b128 v[180:183], v19 offset:8192
    s_waitcnt lgkmcnt(3)
    v_mfma_f32_32x32x16_bf16 v[80:95], v[184:187], v[168:171], v[80:95]
    ds_read_b128 v[184:187], v20 offset:8192
    s_waitcnt lgkmcnt(3)
    v_mfma_f32_32x32x16_bf16 v[80:95], v[188:191], v[172:175], v[80:95]
    ds_read_b128 v[188:191], v21 offset:8192
    s_waitcnt lgkmcnt(3)
    v_mfma_f32_32x32x16_bf16 v[96:111], v[176:179], v[160:163], v[96:111]
    ds_read_b128 v[176:179], v18 offset:12288
    s_waitcnt lgkmcnt(3)
    v_mfma_f32_32x32x16_bf16 v[96:111], v[180:183], v[164:167], v[96:111]
    ds_read_b128 v[180:183], v19 offset:12288
    s_waitcnt lgkmcnt(3)
    v_mfma_f32_32x32x16_bf16 v[96:111], v[184:187], v[168:171], v[96:111]
    ds_read_b128 v[184:187], v20 offset:12288
    s_waitcnt lgkmcnt(3)
    v_mfma_f32_32x32x16_bf16 v[96:111], v[188:191], v[172:175], v[96:111]
    ds_read_b128 v[188:191], v21 offset:12288
    s_waitcnt lgkmcnt(3)
    v_mfma_f32_32x32x16_bf16 v[112:127], v[176:179], v[160:163], v[112:127]
    s_waitcnt lgkmcnt(2)
    v_mfma_f32_32x32x16_bf16 v[112:127], v[180:183], v[164:167], v[112:127]
    s_waitcnt lgkmcnt(1)
    v_mfma_f32_32x32x16_bf16 v[112:127], v[184:187], v[168:171], v[112:127]
    s_waitcnt lgkmcnt(0)
    v_mfma_f32_32x32x16_bf16 v[112:127], v[188:191], v[172:175], v[112:127]
    s_barrier
    v_xor_b32 v10, 32768, v10
    v_xor_b32 v11, 32768, v11
    v_xor_b32 v12, 32768, v12
    v_xor_b32 v13, 32768, v13
    v_xor_b32 v14, 32768, v14
    v_xor_b32 v15, 32768, v15
    v_xor_b32 v16, 32768, v16
    v_xor_b32 v17, 32768, v17
    v_xor_b32 v18, 32768, v18
    v_xor_b32 v19, 32768, v19
    v_xor_b32 v20, 32768, v20
    v_xor_b32 v21, 32768, v21
    v_subrev_u32 v26, 64, v26
    s_add_u32 s48, s48, 1
    s_cmp_lt_u32 s48, s22
    s_cbranch_scc1 Lt_20
    v_mov_b32 v2, v23
    s_nop 1
    v_permlane32_swap_b32 v23, v2
    s_nop 1
    v_add_f32 v23, v23, v2
    v_rcp_f32 v23, v23
    s_nop 7
    s_add_u32 s41, s40, 71303168
    v_mul_f32 v64, v64, v23
    v_mul_f32 v65, v65, v23
    v_mul_f32 v66, v66, v23
    v_mul_f32 v67, v67, v23
    v_mul_f32 v68, v68, v23
    v_mul_f32 v69, v69, v23
    v_mul_f32 v70, v70, v23
    v_mul_f32 v71, v71, v23
    v_cvt_pk_bf16_f32 v176, v64, v65
    v_cvt_pk_bf16_f32 v177, v66, v67
    v_cvt_pk_bf16_f32 v178, v68, v69
    v_cvt_pk_bf16_f32 v179, v70, v71
    buffer_store_dwordx4 v[176:179], v27, s[8:11], s41 offen offset:0
    s_nop 1
    v_mul_f32 v72, v72, v23
    v_mul_f32 v73, v73, v23
    v_mul_f32 v74, v74, v23
    v_mul_f32 v75, v75, v23
    v_mul_f32 v76, v76, v23
    v_mul_f32 v77, v77, v23
    v_mul_f32 v78, v78, v23
    v_mul_f32 v79, v79, v23
    v_cvt_pk_bf16_f32 v176, v72, v73
    v_cvt_pk_bf16_f32 v177, v74, v75
    v_cvt_pk_bf16_f32 v178, v76, v77
    v_cvt_pk_bf16_f32 v179, v78, v79
    buffer_store_dwordx4 v[176:179], v27, s[8:11], s41 offen offset:32
    s_nop 1
    v_mul_f32 v80, v80, v23
    v_mul_f32 v81, v81, v23
    v_mul_f32 v82, v82, v23
    v_mul_f32 v83, v83, v23
    v_mul_f32 v84, v84, v23
    v_mul_f32 v85, v85, v23
    v_mul_f32 v86, v86, v23
    v_mul_f32 v87, v87, v23
    v_cvt_pk_bf16_f32 v176, v80, v81
    v_cvt_pk_bf16_f32 v177, v82, v83
    v_cvt_pk_bf16_f32 v178, v84, v85
    v_cvt_pk_bf16_f32 v179, v86, v87
    buffer_store_dwordx4 v[176:179], v27, s[8:11], s41 offen offset:64
    s_nop 1
    v_mul_f32 v88, v88, v23
    v_mul_f32 v89, v89, v23
    v_mul_f32 v90, v90, v23
    v_mul_f32 v91, v91, v23
    v_mul_f32 v92, v92, v23
    v_mul_f32 v93, v93, v23
    v_mul_f32 v94, v94, v23
    v_mul_f32 v95, v95, v23
    v_cvt_pk_bf16_f32 v176, v88, v89
    v_cvt_pk_bf16_f32 v177, v90, v91
    v_cvt_pk_bf16_f32 v178, v92, v93
    v_cvt_pk_bf16_f32 v179, v94, v95
    buffer_store_dwordx4 v[176:179], v27, s[8:11], s41 offen offset:96
    s_nop 1
    v_mul_f32 v96, v96, v23
    v_mul_f32 v97, v97, v23
    v_mul_f32 v98, v98, v23
    v_mul_f32 v99, v99, v23
    v_mul_f32 v100, v100, v23
    v_mul_f32 v101, v101, v23
    v_mul_f32 v102, v102, v23
    v_mul_f32 v103, v103, v23
    v_cvt_pk_bf16_f32 v176, v96, v97
    v_cvt_pk_bf16_f32 v177, v98, v99
    v_cvt_pk_bf16_f32 v178, v100, v101
    v_cvt_pk_bf16_f32 v179, v102, v103
    buffer_store_dwordx4 v[176:179], v27, s[8:11], s41 offen offset:128
    s_nop 1
    v_mul_f32 v104, v104, v23
    v_mul_f32 v105, v105, v23
    v_mul_f32 v106, v106, v23
    v_mul_f32 v107, v107, v23
    v_mul_f32 v108, v108, v23
    v_mul_f32 v109, v109, v23
    v_mul_f32 v110, v110, v23
    v_mul_f32 v111, v111, v23
    v_cvt_pk_bf16_f32 v176, v104, v105
    v_cvt_pk_bf16_f32 v177, v106, v107
    v_cvt_pk_bf16_f32 v178, v108, v109
    v_cvt_pk_bf16_f32 v179, v110, v111
    buffer_store_dwordx4 v[176:179], v27, s[8:11], s41 offen offset:160
    s_nop 1
    v_mul_f32 v112, v112, v23
    v_mul_f32 v113, v113, v23
    v_mul_f32 v114, v114, v23
    v_mul_f32 v115, v115, v23
    v_mul_f32 v116, v116, v23
    v_mul_f32 v117, v117, v23
    v_mul_f32 v118, v118, v23
    v_mul_f32 v119, v119, v23
    v_cvt_pk_bf16_f32 v176, v112, v113
    v_cvt_pk_bf16_f32 v177, v114, v115
    v_cvt_pk_bf16_f32 v178, v116, v117
    v_cvt_pk_bf16_f32 v179, v118, v119
    buffer_store_dwordx4 v[176:179], v27, s[8:11], s41 offen offset:192
    s_nop 1
    v_mul_f32 v120, v120, v23
    v_mul_f32 v121, v121, v23
    v_mul_f32 v122, v122, v23
    v_mul_f32 v123, v123, v23
    v_mul_f32 v124, v124, v23
    v_mul_f32 v125, v125, v23
    v_mul_f32 v126, v126, v23
    v_mul_f32 v127, v127, v23
    v_cvt_pk_bf16_f32 v176, v120, v121
    v_cvt_pk_bf16_f32 v177, v122, v123
    v_cvt_pk_bf16_f32 v178, v124, v125
    v_cvt_pk_bf16_f32 v179, v126, v127
    buffer_store_dwordx4 v[176:179], v27, s[8:11], s41 offen offset:224
    s_nop 1
Ldone_19:
    s_endpgm
.p2align 8
k3_out_kernel:
    s_cmp_ge_u32 s2, 240
    s_cbranch_scc1 Ldone_25
    s_load_dwordx2 s[6:7], s[0:1], 96
    s_and_b32 s28, s2, 7
    s_lshr_b32 s29, s2, 3
    s_lshl_b32 s51, s28, 1
    s_and_b32 s28, s29, 1
    s_add_u32 s51, s51, s28
    s_lshr_b32 s29, s29, 1
    s_mul_i32 s50, s29, 11
    s_lshr_b32 s50, s50, 5
    s_mul_i32 s28, s50, 3
    s_sub_u32 s52, s29, s28
    s_cmp_ge_u32 s50, 2
    s_cbranch_scc1 Lb_26
    s_load_dwordx2 s[4:5], s[0:1], 40
    s_mov_b32 s20, 8192
    s_mov_b32 s22, 32
    s_mov_b32 s14, 4718592
    s_lshl_b32 s53, s50, 11
    s_mov_b32 s54, 71303168
    s_branch Lc_27
Lb_26:
    s_load_dwordx2 s[4:5], s[0:1], 64
    s_mov_b32 s20, 9216
    s_mov_b32 s22, 24
    s_mov_b32 s14, 5308416
    s_sub_u32 s53, s50, 2
    s_mul_i32 s53, s53, 1536
    s_mov_b32 s54, 50331648
Lc_27:
    s_mov_b32 s21, 1152
    s_waitcnt lgkmcnt(0)
    s_mov_b32 s8, s6
    s_and_b32 s9, s7, 0xffff
    s_mov_b32 s10, 268435456
    s_mov_b32 s11, 0x20000
    s_mov_b32 s12, s4
    s_and_b32 s13, s5, 0xffff
    s_mov_b32 s15, 0x20000
    s_lshl_b32 s23, s51, 7
    s_mul_i32 s23, s23, s20
    s_add_u32 s23, s23, s54
    s_lshl_b32 s28, s53, 1
    s_add_u32 s23, s23, s28
    s_mul_i32 s24, s53, s21
    s_mul_i32 s28, s52, 384
    s_add_u32 s24, s24, s28
    v_lshrrev_b32 v1, 6, v0
    v_and_b32 v0, 63, v0
    s_nop 0
    v_readfirstlane_b32 s25, v1
    s_nop 3
    s_lshr_b32 s26, s25, 1
    s_and_b32 s27, s25, 1
    v_lshrrev_b32 v1, 3, v0
    v_mul_lo_u32 v8, v1, s20
    s_and_b32 s28, s25, 1
    s_lshl_b32 s28, s28, 2
    v_lshrrev_b32 v2, 4, v0
    v_add_u32 v2, s28, v2
    v_and_b32 v2, 7, v2
    v_and_b32 v3, 7, v0
    v_xor_b32 v2, v2, v3
    v_lshlrev_b32 v2, 4, v2
    v_add_u32 v8, v8, v2
    v_mul_lo_u32 v9, v1, s21
    v_bfe_u32 v2, v0, 2, 1
    v_bfe_u32 v3, v0, 4, 1
    v_xor_b32 v2, v2, v3
    v_lshlrev_b32 v2, 2, v2
    v_and_b32 v3, 3, v0
    v_or_b32 v2, v2, v3
    v_lshlrev_b32 v2, 4, v2
    v_add_u32 v9, v9, v2
    v_and_b32 v1, 31, v0
    v_lshlrev_b32 v1, 7, v1
    s_lshl_b32 s28, s26, 13
    v_add_u32 v1, s28, v1
    v_lshrrev_b32 v2, 5, v0
    v_bfe_u32 v3, v0, 1, 3
    v_xor_b32 v2, v2, v3
    v_xor_b32 v3, 0, v2
    v_lshlrev_b32 v3, 4, v3
    v_add_u32 v10, v1, v3
    v_xor_b32 v3, 2, v2
    v_lshlrev_b32 v3, 4, v3
    v_add_u32 v11, v1, v3
    v_xor_b32 v3, 4, v2
    v_lshlrev_b32 v3, 4, v3
    v_add_u32 v12, v1, v3
    v_xor_b32 v3, 6, v2
    v_lshlrev_b32 v3, 4, v3
    v_add_u32 v13, v1, v3
    v_bfe_u32 v1, v0, 2, 2
    v_lshrrev_b32 v2, 5, v0
    v_lshlrev_b32 v2, 2, v2
    v_add_u32 v2, v2, v1
    v_lshlrev_b32 v2, 7, v2
    v_bfe_u32 v3, v0, 4, 1
    v_lshlrev_b32 v3, 5, v3
    v_add_u32 v2, v2, v3
    v_and_b32 v3, 3, v0
    v_lshlrev_b32 v3, 3, v3
    v_add_u32 v2, v2, v3
    v_lshrrev_b32 v1, 1, v1
    s_mul_i32 s28, s27, 3
    s_add_u32 s28, s28, 0
    s_and_b32 s29, s28, 1
    s_lshr_b32 s28, s28, 1
    s_lshl_b32 s28, s28, 13
    s_add_u32 s28, s28, 16384
    v_xor_b32 v3, s29, v1
    v_lshlrev_b32 v3, 6, v3
    v_add_u32 v3, v2, v3
    v_add_u32 v4, s28, v3
    s_mul_i32 s28, s27, 3
    s_add_u32 s28, s28, 1
    s_and_b32 s29, s28, 1
    s_lshr_b32 s28, s28, 1
    s_lshl_b32 s28, s28, 13
    s_add_u32 s28, s28, 16384
    v_xor_b32 v3, s29, v1
    v_lshlrev_b32 v3, 6, v3
    v_add_u32 v3, v2, v3
    v_add_u32 v5, s28, v3
    s_mul_i32 s28, s27, 3
    s_add_u32 s28, s28, 2
    s_and_b32 s29, s28, 1
    s_lshr_b32 s28, s28, 1
    s_lshl_b32 s28, s28, 13
    s_add_u32 s28, s28, 16384
    v_xor_b32 v3, s29, v1
    v_lshlrev_b32 v3, 6, v3
    v_add_u32 v3, v2, v3
    v_add_u32 v6, s28, v3
    s_mul_i32 s28, s25, s20
    s_lshl_b32 s28, s28, 3
    s_add_u32 s28, s28, s23
    s_mul_i32 s29, s20, 32
    s_mov_b32 s32, s28
    s_add_u32 s28, s28, s29
    s_mov_b32 s33, s28
    s_add_u32 s28, s28, s29
    s_mov_b32 s34, s28
    s_add_u32 s28, s28, s29
    s_mov_b32 s35, s28
    s_add_u32 s28, s25, 0
    s_and_b32 s29, s28, 7
    s_mul_i32 s29, s29, s21
    s_lshl_b32 s29, s29, 3
    s_lshr_b32 s28, s28, 3
    s_lshl_b32 s28, s28, 7
    s_add_u32 s28, s28, s29
    s_add_u32 s40, s28, s24
    s_add_u32 s28, s25, 4
    s_and_b32 s29, s28, 7
    s_mul_i32 s29, s29, s21
    s_lshl_b32 s29, s29, 3
    s_lshr_b32 s28, s28, 3
    s_lshl_b32 s28, s28, 7
    s_add_u32 s28, s28, s29
    s_add_u32 s41, s28, s24
    s_add_u32 s28, s25, 8
    s_and_b32 s29, s28, 7
    s_mul_i32 s29, s29, s21
    s_lshl_b32 s29, s29, 3
    s_lshr_b32 s28, s28, 3
    s_lshl_b32 s28, s28, 7
    s_add_u32 s28, s28, s29
    s_add_u32 s42, s28, s24
    s_add_u32 s28, s25, 12
    s_and_b32 s29, s28, 7
    s_mul_i32 s29, s29, s21
    s_lshl_b32 s29, s29, 3
    s_lshr_b32 s28, s28, 3
    s_lshl_b32 s28, s28, 7
    s_add_u32 s28, s28, s29
    s_add_u32 s43, s28, s24
    s_add_u32 s28, s25, 16
    s_and_b32 s29, s28, 7
    s_mul_i32 s29, s29, s21
    s_lshl_b32 s29, s29, 3
    s_lshr_b32 s28, s28, 3
    s_lshl_b32 s28, s28, 7
    s_add_u32 s28, s28, s29
    s_add_u32 s44, s28, s24
    s_add_u32 s28, s25, 20
    s_and_b32 s29, s28, 7
    s_mul_i32 s29, s29, s21
    s_lshl_b32 s29, s29, 3
    s_lshr_b32 s28, s28, 3
    s_lshl_b32 s28, s28, 7
    s_add_u32 s28, s28, s29
    s_add_u32 s45, s28, s24
    s_lshl_b32 s30, s21, 6
    s_lshl_b32 s31, s25, 10
    s_mov_b32 s64, 40960
    v_mov_b32 v56, 0
    v_mov_b32 v57, 0
    v_mov_b32 v58, 0
    v_mov_b32 v59, 0
    v_mov_b32 v60, 0
    v_mov_b32 v61, 0
    v_mov_b32 v62, 0
    v_mov_b32 v63, 0
    v_mov_b32 v64, 0
    v_mov_b32 v65, 0
    v_mov_b32 v66, 0
    v_mov_b32 v67, 0
    v_mov_b32 v68, 0
    v_mov_b32 v69, 0
    v_mov_b32 v70, 0
    v_mov_b32 v71, 0
    v_mov_b32 v72, 0
    v_mov_b32 v73, 0
    v_mov_b32 v74, 0
    v_mov_b32 v75, 0
    v_mov_b32 v76, 0
    v_mov_b32 v77, 0
    v_mov_b32 v78, 0
    v_mov_b32 v79, 0
    v_mov_b32 v80, 0
    v_mov_b32 v81, 0
    v_mov_b32 v82, 0
    v_mov_b32 v83, 0
    v_mov_b32 v84, 0
    v_mov_b32 v85, 0
    v_mov_b32 v86, 0
    v_mov_b32 v87, 0
    v_mov_b32 v88, 0
    v_mov_b32 v89, 0
    v_mov_b32 v90, 0
    v_mov_b32 v91, 0
    v_mov_b32 v92, 0
    v_mov_b32 v93, 0
    v_mov_b32 v94, 0
    v_mov_b32 v95, 0
    v_mov_b32 v96, 0
    v_mov_b32 v97, 0
    v_mov_b32 v98, 0
    v_mov_b32 v99, 0
    v_mov_b32 v100, 0
    v_mov_b32 v101, 0
    v_mov_b32 v102, 0
    v_mov_b32 v103, 0
    v_mov_b32 v104, 0
    v_mov_b32 v105, 0
    v_mov_b32 v106, 0
    v_mov_b32 v107, 0
    v_mov_b32 v108, 0
    v_mov_b32 v109, 0
    v_mov_b32 v110, 0
    v_mov_b32 v111, 0
    v_mov_b32 v112, 0
    v_mov_b32 v113, 0
    v_mov_b32 v114, 0
    v_mov_b32 v115, 0
    v_mov_b32 v116, 0
    v_mov_b32 v117, 0
    v_mov_b32 v118, 0
    v_mov_b32 v119, 0
    v_mov_b32 v120, 0
    v_mov_b32 v121, 0
    v_mov_b32 v122, 0
    v_mov_b32 v123, 0
    v_mov_b32 v124, 0
    v_mov_b32 v125, 0
    v_mov_b32 v126, 0
    v_mov_b32 v127, 0
    v_mov_b32 v128, 0
    v_mov_b32 v129, 0
    v_mov_b32 v130, 0
    v_mov_b32 v131, 0
    v_mov_b32 v132, 0
    v_mov_b32 v133, 0
    v_mov_b32 v134, 0
    v_mov_b32 v135, 0
    v_mov_b32 v136, 0
    v_mov_b32 v137, 0
    v_mov_b32 v138, 0
    v_mov_b32 v139, 0
    v_mov_b32 v140, 0
    v_mov_b32 v141, 0
    v_mov_b32 v142, 0
    v_mov_b32 v143, 0
    v_mov_b32 v144, 0
    v_mov_b32 v145, 0
    v_mov_b32 v146, 0
    v_mov_b32 v147, 0
    v_mov_b32 v148, 0
    v_mov_b32 v149, 0
    v_mov_b32 v150, 0
    v_mov_b32 v151, 0
    s_add_u32 m0, s31, 0
    s_nop 0
    buffer_load_dwordx4 v8, s[8:11], s32 offen lds
    s_add_u32 s32, s32, 128
    s_add_u32 m0, s31, 4096
    s_nop 0
    buffer_load_dwordx4 v8, s[8:11], s33 offen lds
    s_add_u32 s33, s33, 128
    s_add_u32 m0, s31, 8192
    s_nop 0
    buffer_load_dwordx4 v8, s[8:11], s34 offen lds
    s_add_u32 s34, s34, 128
    s_add_u32 m0, s31, 12288
    s_nop 0
    buffer_load_dwordx4 v8, s[8:11], s35 offen lds
    s_add_u32 s35, s35, 128
    s_add_u32 m0, s31, 16384
    s_nop 0
    buffer_load_dwordx4 v9, s[12:15], s40 offen lds
    s_add_u32 s40, s40, s30
    s_add_u32 m0, s31, 20480
    s_nop 0
    buffer_load_dwordx4 v9, s[12:15], s41 offen lds
    s_add_u32 s41, s41, s30
    s_add_u32 m0, s31, 24576
    s_nop 0
    buffer_load_dwordx4 v9, s[12:15], s42 offen lds
    s_add_u32 s42, s42, s30
    s_add_u32 m0, s31, 28672
    s_nop 0
    buffer_load_dwordx4 v9, s[12:15], s43 offen lds
    s_add_u32 s43, s43, s30
    s_add_u32 m0, s31, 32768
    s_nop 0
    buffer_load_dwordx4 v9, s[12:15], s44 offen lds
    s_add_u32 s44, s44, s30
    s_add_u32 m0, s31, 36864
    s_nop 0
    buffer_load_dwordx4 v9, s[12:15], s45 offen lds
    s_add_u32 s45, s45, s30
    s_add_u32 s31, s31, 40960
    s_add_u32 m0, s31, 0
    s_nop 0
    buffer_load_dwordx4 v8, s[8:11], s32 offen lds
    s_add_u32 s32, s32, 128
    s_add_u32 m0, s31, 4096
    s_nop 0
    buffer_load_dwordx4 v8, s[8:11], s33 offen lds
    s_add_u32 s33, s33, 128
    s_add_u32 m0, s31, 8192
    s_nop 0
    buffer_load_dwordx4 v8, s[8:11], s34 offen lds
    s_add_u32 s34, s34, 128
    s_add_u32 m0, s31, 12288
    s_nop 0
    buffer_load_dwordx4 v8, s[8:11], s35 offen lds
    s_add_u32 s35, s35, 128
    s_add_u32 m0, s31, 16384
    s_nop 0
    buffer_load_dwordx4 v9, s[12:15], s40 offen lds
    s_add_u32 s40, s40, s30
    s_add_u32 m0, s31, 20480
    s_nop 0
    buffer_load_dwordx4 v9, s[12:15], s41 offen lds
    s_add_u32 s41, s41, s30
    s_add_u32 m0, s31, 24576
    s_nop 0
    buffer_load_dwordx4 v9, s[12:15], s42 offen lds
    s_add_u32 s42, s42, s30
    s_add_u32 m0, s31, 28672
    s_nop 0
    buffer_load_dwordx4 v9, s[12:15], s43 offen lds
    s_add_u32 s43, s43, s30
    s_add_u32 m0, s31, 32768
    s_nop 0
    buffer_load_dwordx4 v9, s[12:15], s44 offen lds
    s_add_u32 s44, s44, s30
    s_add_u32 m0, s31, 36864
    s_nop 0
    buffer_load_dwordx4 v9, s[12:15], s45 offen lds
    s_add_u32 s45, s45, s30
    s_add_u32 s31, s31, 40960
    s_mov_b32 s48, 0
    s_mov_b32 s63, 0
    s_mov_b32 s60, 40960
    s_mov_b32 s61, -81920
Lk_28:
    s_add_u32 s49, s48, 1
    s_cmp_lt_u32 s49, s22
    s_cbranch_scc0 Lw0_29
    s_waitcnt vmcnt(10)
    s_branch Lwj_30
Lw0_29:
    s_waitcnt vmcnt(0)
Lwj_30:
    s_barrier
    s_add_u32 s49, s48, 2
    s_cmp_lt_u32 s49, s22
    s_cbranch_scc0 Lnd_31
    s_add_u32 m0, s31, 0
    s_nop 0
    buffer_load_dwordx4 v8, s[8:11], s32 offen lds
    s_add_u32 s32, s32, 128
    s_add_u32 m0, s31, 4096
    s_nop 0
    buffer_load_dwordx4 v8, s[8:11], s33 offen lds
    s_add_u32 s33, s33, 128
    s_add_u32 m0, s31, 8192
    s_nop 0
    buffer_load_dwordx4 v8, s[8:11], s34 offen lds
    s_add_u32 s34, s34, 128
    s_add_u32 m0, s31, 12288
    s_nop 0
    buffer_load_dwordx4 v8, s[8:11], s35 offen lds
    s_add_u32 s35, s35, 128
    s_add_u32 m0, s31, 16384
    s_nop 0
    buffer_load_dwordx4 v9, s[12:15], s40 offen lds
    s_add_u32 s40, s40, s30
    s_add_u32 m0, s31, 20480
    s_nop 0
    buffer_load_dwordx4 v9, s[12:15], s41 offen lds
    s_add_u32 s41, s41, s30
    s_add_u32 m0, s31, 24576
    s_nop 0
    buffer_load_dwordx4 v9, s[12:15], s42 offen lds
    s_add_u32 s42, s42, s30
    s_add_u32 m0, s31, 28672
    s_nop 0
    buffer_load_dwordx4 v9, s[12:15], s43 offen lds
    s_add_u32 s43, s43, s30
    s_add_u32 m0, s31, 32768
    s_nop 0
    buffer_load_dwordx4 v9, s[12:15], s44 offen lds
    s_add_u32 s44, s44, s30
    s_add_u32 m0, s31, 36864
    s_nop 0
    buffer_load_dwordx4 v9, s[12:15], s45 offen lds
    s_add_u32 s45, s45, s30
Lnd_31:
    ds_read_b128 v[16:19], v10 offset:0
    ds_read_b128 v[20:23], v10 offset:4096
    ds_read_b64_tr_b16 v[32:33], v4 offset:0
    ds_read_b64_tr_b16 v[34:35], v4 offset:1024
    ds_read_b64_tr_b16 v[36:37], v5 offset:0
    ds_read_b64_tr_b16 v[38:39], v5 offset:1024
    ds_read_b64_tr_b16 v[40:41], v6 offset:0
    ds_read_b64_tr_b16 v[42:43], v6 offset:1024
    ds_read_b128 v[24:27], v11 offset:0
    ds_read_b128 v[28:31], v11 offset:4096
    ds_read_b64_tr_b16 v[44:45], v4 offset:2048
    ds_read_b64_tr_b16 v[46:47], v4 offset:3072
    ds_read_b64_tr_b16 v[48:49], v5 offset:2048
    ds_read_b64_tr_b16 v[50:51], v5 offset:3072
    ds_read_b64_tr_b16 v[52:53], v6 offset:2048
    ds_read_b64_tr_b16 v[54:55], v6 offset:3072
    s_waitcnt lgkmcnt(8)
    v_mfma_f32_32x32x16_bf16 v[56:71], v[32:35], v[16:19], v[56:71]
    v_mfma_f32_32x32x16_bf16 v[72:87], v[36:39], v[16:19], v[72:87]
    v_mfma_f32_32x32x16_bf16 v[88:103], v[40:43], v[16:19], v[88:103]
    v_mfma_f32_32x32x16_bf16 v[104:119], v[32:35], v[20:23], v[104:119]
    v_mfma_f32_32x32x16_bf16 v[120:135], v[36:39], v[20:23], v[120:135]
    v_mfma_f32_32x32x16_bf16 v[136:151], v[40:43], v[20:23], v[136:151]
    ds_read_b128 v[16:19], v12 offset:0
    ds_read_b128 v[20:23], v12 offset:4096
    ds_read_b64_tr_b16 v[32:33], v4 offset:4096
    ds_read_b64_tr_b16 v[34:35], v4 offset:5120
    ds_read_b64_tr_b16 v[36:37], v5 offset:4096
    ds_read_b64_tr_b16 v[38:39], v5 offset:5120
    ds_read_b64_tr_b16 v[40:41], v6 offset:4096
    ds_read_b64_tr_b16 v[42:43], v6 offset:5120
    s_waitcnt lgkmcnt(8)
    v_mfma_f32_32x32x16_bf16 v[56:71], v[44:47], v[24:27], v[56:71]
    v_mfma_f32_32x32x16_bf16 v[72:87], v[48:51], v[24:27], v[72:87]
    v_mfma_f32_32x32x16_bf16 v[88:103], v[52:55], v[24:27], v[88:103]
    v_mfma_f32_32x32x16_bf16 v[104:119], v[44:47], v[28:31], v[104:119]
    v_mfma_f32_32x32x16_bf16 v[120:135], v[48:51], v[28:31], v[120:135]
    v_mfma_f32_32x32x16_bf16 v[136:151], v[52:55], v[28:31], v[136:151]
    ds_read_b128 v[24:27], v13 offset:0
    ds_read_b128 v[28:31], v13 offset:4096
    ds_read_b64_tr_b16 v[44:45], v4 offset:6144
    ds_read_b64_tr_b16 v[46:47], v4 offset:7168
    ds_read_b64_tr_b16 v[48:49], v5 offset:6144
    ds_read_b64_tr_b16 v[50:51], v5 offset:7168
    ds_read_b64_tr_b16 v[52:53], v6 offset:6144
    ds_read_b64_tr_b16 v[54:55], v6 offset:7168
    s_waitcnt lgkmcnt(8)
    v_mfma_f32_32x32x16_bf16 v[56:71], v[32:35], v[16:19], v[56:71]
    v_mfma_f32_32x32x16_bf16 v[72:87], v[36:39], v[16:19], v[72:87]
    v_mfma_f32_32x32x16_bf16 v[88:103], v[40:43], v[16:19], v[88:103]
    v_mfma_f32_32x32x16_bf16 v[104:119], v[32:35], v[20:23], v[104:119]
    v_mfma_f32_32x32x16_bf16 v[120:135], v[36:39], v[20:23], v[120:135]
    v_mfma_f32_32x32x16_bf16 v[136:151], v[40:43], v[20:23], v[136:151]
    s_waitcnt lgkmcnt(0)
    v_mfma_f32_32x32x16_bf16 v[56:71], v[44:47], v[24:27], v[56:71]
    v_mfma_f32_32x32x16_bf16 v[72:87], v[48:51], v[24:27], v[72:87]
    v_mfma_f32_32x32x16_bf16 v[88:103], v[52:55], v[24:27], v[88:103]
    v_mfma_f32_32x32x16_bf16 v[104:119], v[44:47], v[28:31], v[104:119]
    v_mfma_f32_32x32x16_bf16 v[120:135], v[48:51], v[28:31], v[120:135]
    v_mfma_f32_32x32x16_bf16 v[136:151], v[52:55], v[28:31], v[136:151]
    s_cmp_eq_u32 s63, 2
    s_cselect_b32 s64, s61, s60
    s_cselect_b32 s62, -1, s63
    s_add_u32 s63, s62, 1
    v_add_u32 v10, s64, v10
    v_add_u32 v11, s64, v11
    v_add_u32 v12, s64, v12
    v_add_u32 v13, s64, v13
    v_add_u32 v4, s64, v4
    v_add_u32 v5, s64, v5
    v_add_u32 v6, s64, v6
    s_cmp_eq_u32 s63, 1
    s_cselect_b32 s64, s61, s60
    s_add_u32 s31, s31, s64
    s_add_u32 s48, s48, 1
    s_cmp_lt_u32 s48, s22
    s_cbranch_scc1 Lk_28
    s_nop 7
    s_nop 7
    s_mul_i32 s28, s50, 4718592
    s_add_u32 s28, s28, 89128960
    s_lshl_b32 s29, s51, 7
    s_mul_i32 s29, s29, 2304
    s_add_u32 s28, s28, s29
    s_mul_i32 s29, s52, 768
    s_add_u32 s28, s28, s29
    s_add_u32 s29, s28, 73728
    v_and_b32 v1, 31, v0
    v_mul_u32_u24 v1, 2304, v1
    v_lshrrev_b32 v2, 5, v0
    v_lshlrev_b32 v2, 4, v2
    v_add_u32 v1, v1, v2
    s_mul_i32 s57, s26, 147456
    s_mul_i32 s58, s27, 384
    s_add_u32 s57, s57, s58
    v_add_u32 v1, s57, v1
    buffer_store_dwordx4 v[56:59], v1, s[8:11], s28 offen offset:0
    buffer_store_dwordx4 v[60:63], v1, s[8:11], s28 offen offset:32
    buffer_store_dwordx4 v[64:67], v1, s[8:11], s28 offen offset:64
    buffer_store_dwordx4 v[68:71], v1, s[8:11], s28 offen offset:96
    buffer_store_dwordx4 v[72:75], v1, s[8:11], s28 offen offset:128
    buffer_store_dwordx4 v[76:79], v1, s[8:11], s28 offen offset:160
    buffer_store_dwordx4 v[80:83], v1, s[8:11], s28 offen offset:192
    buffer_store_dwordx4 v[84:87], v1, s[8:11], s28 offen offset:224
    buffer_store_dwordx4 v[88:91], v1, s[8:11], s28 offen offset:256
    buffer_store_dwordx4 v[92:95], v1, s[8:11], s28 offen offset:288
    buffer_store_dwordx4 v[96:99], v1, s[8:11], s28 offen offset:320
    buffer_store_dwordx4 v[100:103], v1, s[8:11], s28 offen offset:352
    buffer_store_dwordx4 v[104:107], v1, s[8:11], s29 offen offset:0
    buffer_store_dwordx4 v[108:111], v1, s[8:11], s29 offen offset:32
    buffer_store_dwordx4 v[112:115], v1, s[8:11], s29 offen offset:64
    buffer_store_dwordx4 v[116:119], v1, s[8:11], s29 offen offset:96
    buffer_store_dwordx4 v[120:123], v1, s[8:11], s29 offen offset:128
    buffer_store_dwordx4 v[124:127], v1, s[8:11], s29 offen offset:160
    buffer_store_dwordx4 v[128:131], v1, s[8:11], s29 offen offset:192
    buffer_store_dwordx4 v[132:135], v1, s[8:11], s29 offen offset:224
    buffer_store_dwordx4 v[136:139], v1, s[8:11], s29 offen offset:256
    buffer_store_dwordx4 v[140:143], v1, s[8:11], s29 offen offset:288
    buffer_store_dwordx4 v[144:147], v1, s[8:11], s29 offen offset:320
    buffer_store_dwordx4 v[148:151], v1, s[8:11], s29 offen offset:352
Ldone_25:
    s_endpgm
.p2align 8
k4_mix_kernel:
    s_cmp_ge_u32 s2, 576
    s_cbranch_scc1 Ldone_32
    s_load_dwordx2 s[6:7], s[0:1], 96
    s_load_dwordx2 s[4:5], s[0:1], 80
    s_lshl_b32 s3, s2, 8
    v_add_u32 v1, s3, v0
    v_lshlrev_b32 v2, 5, v1
    v_lshlrev_b32 v3, 4, v1
    s_mov_b32 s28, 0x38e38e4
    v_mul_hi_u32 v4, s28, v1
    v_lshlrev_b32 v4, 2, v4
    s_waitcnt lgkmcnt(0)
    s_mov_b32 s8, s6
    s_and_b32 s9, s7, 0xffff
    s_mov_b32 s10, 268435456
    s_mov_b32 s11, 0x20000
    s_mov_b32 s12, s4
    s_and_b32 s13, s5, 0xffff
    s_mov_b32 s14, 2359296
    s_mov_b32 s15, 0x20000
    s_mov_b32 s28, 88080384
    buffer_load_dword v5, v4, s[8:11], s28 offen
    s_mov_b32 s28, 89128960
    buffer_load_dwordx4 v[8:11], v2, s[8:11], s28 offen
    buffer_load_dwordx4 v[12:15], v2, s[8:11], s28 offen offset:16
    s_mov_b32 s28, 93847552
    buffer_load_dwordx4 v[16:19], v2, s[8:11], s28 offen
    buffer_load_dwordx4 v[20:23], v2, s[8:11], s28 offen offset:16
    s_mov_b32 s28, 98566144
    buffer_load_dwordx4 v[24:27], v2, s[8:11], s28 offen
    buffer_load_dwordx4 v[28:31], v2, s[8:11], s28 offen offset:16
    s_mov_b32 s28, 103284736
    buffer_load_dwordx4 v[32:35], v2, s[8:11], s28 offen
    buffer_load_dwordx4 v[36:39], v2, s[8:11], s28 offen offset:16
    s_mov_b32 s28, 108003328
    buffer_load_dwordx4 v[40:43], v2, s[8:11], s28 offen
    buffer_load_dwordx4 v[44:47], v2, s[8:11], s28 offen offset:16
    s_waitcnt vmcnt(0)
    v_sub_f32 v6, 1.0, v5
    v_cvt_pk_bf16_f32 v6, v6, v6
    v_lshlrev_b32 v6, 16, v6
    v_add_f32 v8, v8, v16
    v_add_f32 v24, v24, v32
    v_add_f32 v24, v24, v40
    v_add_f32 v9, v9, v17
    v_add_f32 v25, v25, v33
    v_add_f32 v25, v25, v41
    v_add_f32 v10, v10, v18
    v_add_f32 v26, v26, v34
    v_add_f32 v26, v26, v42
    v_add_f32 v11, v11, v19
    v_add_f32 v27, v27, v35
    v_add_f32 v27, v27, v43
    v_add_f32 v12, v12, v20
    v_add_f32 v28, v28, v36
    v_add_f32 v28, v28, v44
    v_add_f32 v13, v13, v21
    v_add_f32 v29, v29, v37
    v_add_f32 v29, v29, v45
    v_add_f32 v14, v14, v22
    v_add_f32 v30, v30, v38
    v_add_f32 v30, v30, v46
    v_add_f32 v15, v15, v23
    v_add_f32 v31, v31, v39
    v_add_f32 v31, v31, v47
    v_cvt_pk_bf16_f32 v16, v8, v9
    v_cvt_pk_bf16_f32 v17, v24, v25
    v_lshlrev_b32 v18, 16, v16
    v_and_b32 v19, 0xffff0000, v16
    v_lshlrev_b32 v20, 16, v17
    v_and_b32 v21, 0xffff0000, v17
    v_mul_f32 v18, v5, v18
    v_mul_f32 v19, v5, v19
    v_mul_f32 v20, v6, v20
    v_mul_f32 v21, v6, v21
    v_cvt_pk_bf16_f32 v16, v18, v19
    v_cvt_pk_bf16_f32 v17, v20, v21
    v_lshlrev_b32 v18, 16, v16
    v_and_b32 v19, 0xffff0000, v16
    v_lshlrev_b32 v20, 16, v17
    v_and_b32 v21, 0xffff0000, v17
    v_add_f32 v18, v18, v20
    v_add_f32 v19, v19, v21
    v_cvt_pk_bf16_f32 v48, v18, v19
    v_cvt_pk_bf16_f32 v16, v10, v11
    v_cvt_pk_bf16_f32 v17, v26, v27
    v_lshlrev_b32 v18, 16, v16
    v_and_b32 v19, 0xffff0000, v16
    v_lshlrev_b32 v20, 16, v17
    v_and_b32 v21, 0xffff0000, v17
    v_mul_f32 v18, v5, v18
    v_mul_f32 v19, v5, v19
    v_mul_f32 v20, v6, v20
    v_mul_f32 v21, v6, v21
    v_cvt_pk_bf16_f32 v16, v18, v19
    v_cvt_pk_bf16_f32 v17, v20, v21
    v_lshlrev_b32 v18, 16, v16
    v_and_b32 v19, 0xffff0000, v16
    v_lshlrev_b32 v20, 16, v17
    v_and_b32 v21, 0xffff0000, v17
    v_add_f32 v18, v18, v20
    v_add_f32 v19, v19, v21
    v_cvt_pk_bf16_f32 v49, v18, v19
    v_cvt_pk_bf16_f32 v16, v12, v13
    v_cvt_pk_bf16_f32 v17, v28, v29
    v_lshlrev_b32 v18, 16, v16
    v_and_b32 v19, 0xffff0000, v16
    v_lshlrev_b32 v20, 16, v17
    v_and_b32 v21, 0xffff0000, v17
    v_mul_f32 v18, v5, v18
    v_mul_f32 v19, v5, v19
    v_mul_f32 v20, v6, v20
    v_mul_f32 v21, v6, v21
    v_cvt_pk_bf16_f32 v16, v18, v19
    v_cvt_pk_bf16_f32 v17, v20, v21
    v_lshlrev_b32 v18, 16, v16
    v_and_b32 v19, 0xffff0000, v16
    v_lshlrev_b32 v20, 16, v17
    v_and_b32 v21, 0xffff0000, v17
    v_add_f32 v18, v18, v20
    v_add_f32 v19, v19, v21
    v_cvt_pk_bf16_f32 v50, v18, v19
    v_cvt_pk_bf16_f32 v16, v14, v15
    v_cvt_pk_bf16_f32 v17, v30, v31
    v_lshlrev_b32 v18, 16, v16
    v_and_b32 v19, 0xffff0000, v16
    v_lshlrev_b32 v20, 16, v17
    v_and_b32 v21, 0xffff0000, v17
    v_mul_f32 v18, v5, v18
    v_mul_f32 v19, v5, v19
    v_mul_f32 v20, v6, v20
    v_mul_f32 v21, v6, v21
    v_cvt_pk_bf16_f32 v16, v18, v19
    v_cvt_pk_bf16_f32 v17, v20, v21
    v_lshlrev_b32 v18, 16, v16
    v_and_b32 v19, 0xffff0000, v16
    v_lshlrev_b32 v20, 16, v17
    v_and_b32 v21, 0xffff0000, v17
    v_add_f32 v18, v18, v20
    v_add_f32 v19, v19, v21
    v_cvt_pk_bf16_f32 v51, v18, v19
    buffer_store_dwordx4 v[48:51], v3, s[12:15], 0 offen
Ldone_32:
    s_endpgm
.section .rodata,"a"
.p2align 6
.amdhsa_kernel k1_proj_kernel
  .amdhsa_next_free_vgpr 112
  .amdhsa_next_free_sgpr 100
  .amdhsa_accum_offset 112
  .amdhsa_group_segment_fixed_size 0
  .amdhsa_kernarg_size 104
  .amdhsa_user_sgpr_count 2
  .amdhsa_user_sgpr_kernarg_segment_ptr 1
  .amdhsa_system_sgpr_workgroup_id_x 1
.end_amdhsa_kernel
.amdhsa_kernel k2_attn_kernel
  .amdhsa_next_free_vgpr 192
  .amdhsa_next_free_sgpr 100
  .amdhsa_accum_offset 192
  .amdhsa_group_segment_fixed_size 0
  .amdhsa_kernarg_size 104
  .amdhsa_user_sgpr_count 2
  .amdhsa_user_sgpr_kernarg_segment_ptr 1
  .amdhsa_system_sgpr_workgroup_id_x 1
.end_amdhsa_kernel
.amdhsa_kernel k3_out_kernel
  .amdhsa_next_free_vgpr 152
  .amdhsa_next_free_sgpr 100
  .amdhsa_accum_offset 152
  .amdhsa_group_segment_fixed_size 0
  .amdhsa_kernarg_size 104
  .amdhsa_user_sgpr_count 2
  .amdhsa_user_sgpr_kernarg_segment_ptr 1
  .amdhsa_system_sgpr_workgroup_id_x 1
.end_amdhsa_kernel
.amdhsa_kernel k4_mix_kernel
  .amdhsa_next_free_vgpr 52
  .amdhsa_next_free_sgpr 100
  .amdhsa_accum_offset 52
  .amdhsa_group_segment_fixed_size 0
  .amdhsa_kernarg_size 104
  .amdhsa_user_sgpr_count 2
  .amdhsa_user_sgpr_kernarg_segment_ptr 1
  .amdhsa_system_sgpr_workgroup_id_x 1
.end_amdhsa_kernel
```
